```python
import torch

def _softmax(x, axis=-1):
    return torch.softmax(x, dim=axis)
def _gelu(x):
    return torch.nn.functional.gelu(x, approximate="tanh")
def _silu(x):
    return torch.nn.functional.silu(x)
def _sigmoid(x):
    return torch.sigmoid(x)
def _layernorm(x, axis=-1, eps=1e-5):
    m = x.mean(dim=axis, keepdim=True)
    v = x.var(dim=axis, keepdim=True, unbiased=False)
    return (x - m) / torch.sqrt(v + eps)
def _scatter_add(tgt, idx, src, axis=0):
    return tgt.clone().index_add_(axis, idx, src)
def _segment_sum(src, seg, n):
    out = torch.zeros((n,) + src.shape[1:], dtype=src.dtype)
    return out.index_add_(0, seg, src)
def _pad(x, pw):
    flat = tuple(v for pair in reversed(pw) for v in pair)
    return torch.nn.functional.pad(x, flat)

kernel_name = 'gated_mix__mha_block__dense_activation_mish__prompt'

def setup_inputs():

    _w = (lambda a: (lambda t: t.to(torch.bfloat16) if t.is_floating_point() else t)(torch.as_tensor(a)))
    def _A_setup():
        B, S, D, H = 1, 2048, 512, 32
        return {
            "x": _w((lambda *s: torch.randn(*s, dtype=torch.bfloat16) * 0.05)(B, S, D)),
            "wqkv": _w((lambda *s: torch.randn(*s, dtype=torch.bfloat16) * 0.8)(D, 3 * D)),
            "wo": _w((lambda *s: torch.randn(*s, dtype=torch.bfloat16) * 0.05)(D, D)),
        }
    _A_in = _A_setup()

    def _B_setup():
        B, S, D, F = 1, 2048, 512, 1792
        return {
            "x": _w((lambda *s: torch.randn(*s, dtype=torch.bfloat16) * 0.05)(B, S, D)),
            "w1": _w((lambda *s: torch.randn(*s, dtype=torch.bfloat16) * 12.8)(D, F) * (D ** -0.5)),
            "b1": _w((lambda *s: torch.randn(*s, dtype=torch.bfloat16) * 0.2)(F)),
            "w2": _w((lambda *s: torch.randn(*s, dtype=torch.bfloat16) * 0.1)(F, D) * (F ** -0.5)),
        }
    _B_in = _B_setup()

    return {
        "A_x": _A_in["x"],
        "A_wqkv": _A_in["wqkv"],
        "A_wo": _A_in["wo"],
        "B_x": _B_in["x"],
        "B_w1": _B_in["w1"],
        "B_b1": _B_in["b1"],
        "B_w2": _B_in["w2"],
        "gate_w": _w((lambda *s: torch.randn(*s, dtype=torch.bfloat16) * 0.05)(512) * 16.0),
    }

def reference(A_x, A_wqkv, A_wo, B_x, B_w1, B_b1, B_w2, gate_w):
    def _A_ref(x, wqkv, wo):
        B, S, D = x.shape
        H = 32
        Dh = D // H
        qkv = (lambda x, *d: x.permute(*d))((x @ wqkv).reshape(B, S, 3, H, Dh), 2, 0, 3, 1, 4)
        q, k, v = qkv[0], qkv[1], qkv[2]
        scores = torch.einsum("bhqd,bhkd->bhqk", q, k) * (Dh ** -0.5)
        p = _softmax(scores, axis=-1)
        o = torch.einsum("bhqk,bhkd->bhqd", p, v)
        return (lambda x, *d: x.permute(*d))(o, 0, 2, 1, 3).reshape(B, S, D) @ wo

    def _B_ref(x, w1, b1, w2):
        h = torch.einsum("bsd,df->bsf", x, w1) + b1
        sp = torch.log1p(torch.exp(-torch.abs(h))) + torch.where(h > 0, h, torch.zeros_like(h))
        act = h * torch.tanh(sp)
        return torch.einsum("bsf,fd->bsd", act, w2)

    x = A_x
    g = _sigmoid((x * gate_w).sum(-1, keepdims=True))
    a = _A_ref(x, A_wqkv, A_wo)
    b = _B_ref(x, B_w1, B_b1, B_w2)
    return g * a + (1 - g) * b
```

```asm
; @launch grid=(256,1,1) block=(768,1,1) lds=163840
.amdgcn_target "amdgcn-amd-amdhsa--gfx950"
.text
.globl gated_mix__mha_block__dense_activation_mish__prompt_kernel
.p2align 8
.type gated_mix__mha_block__dense_activation_mish__prompt_kernel,@function
gated_mix__mha_block__dense_activation_mish__prompt_kernel:

    s_cmp_ge_u32 s2, 256
    s_cbranch_scc1 MK_END
    s_load_dwordx2 s[8:9], s[0:1], 0
    s_load_dwordx2 s[12:13], s[0:1], 8
    s_load_dwordx2 s[20:21], s[0:1], 32
    s_load_dwordx2 s[16:17], s[0:1], 16
    s_load_dwordx2 s[24:25], s[0:1], 40
    s_load_dwordx2 s[28:29], s[0:1], 48
    s_load_dwordx2 s[32:33], s[0:1], 56
    s_load_dwordx2 s[36:37], s[0:1], 80
    s_load_dwordx2 s[100:101], s[0:1], 72
    s_mov_b32 s10, 2097152
    s_mov_b32 s11, 0x00020000
    s_mov_b32 s14, 1572864
    s_mov_b32 s15, 0x00020000
    s_mov_b32 s22, 1835008
    s_mov_b32 s23, 0x00020000
    s_mov_b32 s38, 33554432
    s_mov_b32 s39, 0x00020000
    v_and_b32 v1, 63, v0
    v_lshrrev_b32 v2, 6, v0
    s_and_b32 s44, s2, 1
    v_readfirstlane_b32 s40, v2
    s_lshl_b32 s44, s44, 3
    s_bfe_u32 s45, s2, 0x30003
    s_add_u32 s42, s44, s45
    s_and_b32 s41, s2, 6
    s_bfe_u32 s44, s2, 0x10006
    s_add_u32 s41, s41, s44
    s_lshr_b32 s47, s40, 2
    s_and_b32 s44, s40, 3
    s_lshl_b32 s43, s42, 2
    s_add_u32 s43, s43, s44
    v_lshrrev_b32 v2, 3, v1
    v_and_b32 v3, 7, v1
    v_lshrrev_b32 v4, 1, v2
    v_xor_b32 v5, v3, v4
    v_lshlrev_b32 v6, 10, v2
    v_lshl_add_u32 v6, v5, 4, v6
    v_xor_b32 v7, 64, v6
    v_and_b32 v4, 1, v4
    v_lshlrev_b32 v4, 2, v4
    v_xor_b32 v5, v3, v4
    v_lshlrev_b32 v5, 4, v5
    v_mul_u32_u24 v8, 3072, v2
    v_add_u32 v8, v8, v5
    v_mul_u32_u24 v9, 3584, v2
    v_add_u32 v9, v9, v5
    v_lshl_add_u32 v22, v2, 10, v5
    v_lshlrev_b32 v11, 4, v1
    s_and_b32 s44, s2, 7
    s_lshl_b32 s44, s44, 2
    s_bfe_u32 s45, s2, 0x20003
    s_add_u32 s95, s44, s45
    s_lshr_b32 s96, s2, 5
    s_cmp_ge_u32 s2, 128
    s_cbranch_scc1 P1_B
    s_lshl_b32 s59, s41, 7
    s_xor_b32 s60, s59, 512
    s_add_u32 s60, s60, 1024
    s_add_u32 s61, s59, 2048
    s_lshl_b32 s62, s41, 6
    s_add_u32 s62, s62, 3072
    v_lshrrev_b32 v2, 2, v1
    v_mul_u32_u24 v10, 3584, v2
    v_and_b32 v2, 3, v1
    v_lshl_add_u32 v10, v2, 4, v10
    s_cmp_ge_u32 s40, 8
    s_cbranch_scc0 P1A_COMP
    s_sub_u32 s63, s40, 8
    s_and_b32 s57, s2, 7
    s_bfe_u32 s44, s2, 0x30003
    s_and_b32 s44, s44, 1
    s_add_u32 s57, s57, s44
    s_and_b32 s57, s57, 7
    s_mov_b32 s58, 98304
    s_lshl_b32 s53, s42, 2
    s_add_u32 s53, s53, s63
    s_lshl_b32 s53, s53, 15
    s_mul_i32 s45, s63, 49152
    s_mul_i32 s46, s63, 57344
    s_add_u32 s49, s59, s45
    s_add_u32 s50, s60, s45
    s_add_u32 s51, s61, s46
    s_add_u32 s52, s62, s46
    s_mov_b32 s48, 0
    s_waitcnt lgkmcnt(0)
P1A_LD0:
    s_lshl_b32 s97, s57, 7
    s_add_u32 s97, s97, s53
    s_mul_i32 s98, s57, 196608
    s_lshl_b32 s44, s63, 10
    s_add_u32 s56, s58, s44
    s_add_u32 s55, s56, s44
    s_lshl_b32 s44, s44, 1
    s_add_u32 s54, s55, s44
    s_add_u32 m0, s54, 0
    s_add_u32 s7, s97, 0
    buffer_load_dwordx4 v6, s[8:11], s7 offen lds
    s_add_u32 m0, s54, 1024
    s_add_u32 s7, s97, 8192
    buffer_load_dwordx4 v7, s[8:11], s7 offen lds
    s_add_u32 m0, s54, 2048
    s_add_u32 s7, s97, 16384
    buffer_load_dwordx4 v6, s[8:11], s7 offen lds
    s_add_u32 m0, s54, 3072
    s_add_u32 s7, s97, 24576
    buffer_load_dwordx4 v7, s[8:11], s7 offen lds
    s_add_u32 m0, s55, 16384
    s_add_u32 s7, s98, s49
    buffer_load_dwordx4 v8, s[12:15], s7 offen lds
    s_add_u32 m0, s55, 17408
    s_add_u32 s7, s98, s49
    s_add_u32 s7, s7, 24576
    buffer_load_dwordx4 v8, s[12:15], s7 offen lds
    s_add_u32 m0, s55, 24576
    s_add_u32 s7, s98, s50
    buffer_load_dwordx4 v8, s[12:15], s7 offen lds
    s_add_u32 m0, s55, 25600
    s_add_u32 s7, s98, s50
    s_add_u32 s7, s7, 24576
    buffer_load_dwordx4 v8, s[12:15], s7 offen lds
    s_add_u32 s57, s57, 1
    s_and_b32 s57, s57, 7
    s_add_u32 s58, s58, 32768
    s_cmp_eq_u32 s58, 163840
    s_cselect_b32 s58, 0, s58
    s_add_u32 s48, s48, 1
    s_cmp_lt_u32 s48, 2
    s_cbranch_scc1 P1A_LD0
    s_waitcnt vmcnt(8)
    s_barrier
    s_cmp_lt_u32 s48, 8
    s_cbranch_scc1 P1A_LD0
P1A_LD1:
    s_lshl_b32 s97, s57, 7
    s_add_u32 s97, s97, s53
    s_mul_i32 s98, s57, 229376
    s_lshl_b32 s44, s63, 10
    s_add_u32 s56, s58, s44
    s_add_u32 s55, s56, s44
    s_lshl_b32 s44, s44, 1
    s_add_u32 s54, s55, s44
    s_add_u32 m0, s54, 0
    s_add_u32 s7, s97, 0
    buffer_load_dwordx4 v6, s[8:11], s7 offen lds
    s_add_u32 m0, s54, 1024
    s_add_u32 s7, s97, 8192
    buffer_load_dwordx4 v7, s[8:11], s7 offen lds
    s_add_u32 m0, s54, 2048
    s_add_u32 s7, s97, 16384
    buffer_load_dwordx4 v6, s[8:11], s7 offen lds
    s_add_u32 m0, s54, 3072
    s_add_u32 s7, s97, 24576
    buffer_load_dwordx4 v7, s[8:11], s7 offen lds
    s_add_u32 m0, s55, 16384
    s_add_u32 s7, s98, s51
    buffer_load_dwordx4 v9, s[20:23], s7 offen lds
    s_add_u32 m0, s55, 17408
    s_add_u32 s7, s98, s51
    s_add_u32 s7, s7, 28672
    buffer_load_dwordx4 v9, s[20:23], s7 offen lds
    s_add_u32 m0, s56, 24576
    s_add_u32 s7, s98, s52
    buffer_load_dwordx4 v10, s[20:23], s7 offen lds
    s_add_u32 s57, s57, 1
    s_and_b32 s57, s57, 7
    s_add_u32 s58, s58, 32768
    s_cmp_eq_u32 s58, 163840
    s_cselect_b32 s58, 0, s58
    s_add_u32 s48, s48, 1
    s_waitcnt vmcnt(7)
    s_barrier
    s_cmp_lt_u32 s48, 16
    s_cbranch_scc1 P1A_LD1
    s_mov_b32 s48, 1
    s_branch P2_SHADOW
P1A_COMP:
    s_waitcnt lgkmcnt(0)
    s_getpc_b64 s[82:83]
PFC_p1A:
    v_lshlrev_b32 v25, 7, v0
    v_min_u32 v26, MK_END-PFC_p1A-4, v25
    global_load_dword v27, v26, s[82:83]
    s_mov_b32 s26, 3584
    s_mov_b32 s27, 0x00020000
    s_mov_b32 s34, 1024
    s_mov_b32 s35, 0x00020000
    s_lshl_b32 s44, s96, 3
    s_add_u32 s44, s44, s40
    s_lshl_b32 s44, s44, 5
    s_add_u32 s44, s44, s95
    s_lshl_b32 s44, s44, 10
    s_add_u32 s97, s44, 20971520
    s_or_b32 s44, s2, s40
    s_cmp_lg_u32 s44, 0
    s_cbranch_scc1 P1_NONONCE
    s_memrealtime s[50:51]
    v_mov_b32 v2, 0
    s_waitcnt lgkmcnt(0)
    s_or_b32 s50, s50, 1
    v_mov_b32 v52, s50
    v_mov_b32 v53, s51
    s_mov_b64 exec, 1
    global_store_dwordx2 v2, v[52:53], s[100:101] sc0 sc1
    s_mov_b64 exec, -1
P1_NONONCE:
    v_mov_b32 v140, 0
    v_mov_b32 v141, 0
    v_mov_b32 v142, 0
    v_mov_b32 v143, 0
    v_mov_b32 v144, 0
    v_mov_b32 v145, 0
    s_lshl_b32 s94, s42, 4
    s_add_u32 s94, s94, s41
    s_lshl_b32 s94, s94, 3
    s_add_u32 s94, s94, s40
    s_lshl_b32 s45, s94, 10
    buffer_load_dwordx4 v[150:153], v11, s[8:11], s45 offen
    buffer_load_dwordx4 v[154:157], v11, s[32:35], 0 offen
    v_and_b32 v2, 31, v1
    v_lshlrev_b32 v2, 1, v2
    s_lshl_b32 s45, s47, 6
    s_add_u32 s7, s61, s45
    buffer_load_ushort v140, v2, s[24:27], s7 offen
    buffer_load_ushort v142, v2, s[24:27], s62 offen
    v_and_b32 v2, 31, v1
    v_lshrrev_b32 v3, 5, v1
    v_bfe_u32 v4, v2, 1, 3
    v_xor_b32 v4, v4, v3
    v_lshlrev_b32 v5, 7, v2
    s_and_b32 s44, s40, 3
    s_lshl_b32 s44, s44, 12
    s_add_u32 s44, s44, 98304
    v_add_u32 v5, s44, v5
    v_lshl_add_u32 v5, v4, 4, v5
    v_mov_b32 v14, v5
    v_xor_b32 v15, 32, v14
    v_xor_b32 v16, 64, v14
    v_xor_b32 v17, 96, v14
    v_bfe_u32 v2, v1, 2, 2
    v_and_b32 v4, 3, v1
    v_bfe_u32 v5, v1, 4, 1
    v_lshlrev_b32 v18, 10, v3
    v_lshl_add_u32 v18, v2, 7, v18
    v_lshl_add_u32 v18, v5, 5, v18
    v_lshl_add_u32 v18, v4, 3, v18
    v_lshrrev_b32 v25, 1, v2
    v_lshl_add_u32 v18, v25, 6, v18
    v_xor_b32 v18, s45, v18
    v_add_u32 v18, 114688, v18
    v_lshlrev_b32 v13, 9, v3
    v_lshl_add_u32 v13, v2, 6, v13
    v_lshl_add_u32 v13, v5, 5, v13
    v_lshl_add_u32 v13, v4, 3, v13
    v_add_u32 v13, 122880, v13
    v_and_b32 v12, 0x33, v1
    v_bfe_u32 v26, v1, 2, 1
    v_lshl_or_b32 v12, v26, 3, v12
    v_bfe_u32 v26, v1, 3, 1
    v_lshl_or_b32 v12, v26, 2, v12
    v_lshlrev_b32 v12, 4, v12
    s_lshl_b32 s98, s40, 11
    v_cmp_gt_u32 vcc, 32, v1
    v_mov_b32 v147, 0
    v_mov_b32 v148, 0
    v_mov_b32 v149, 0
    v_mov_b32 v2, 0x3f80
    v_cndmask_b32 v146, 0, v2, vcc
    s_mov_b32 s84, 0x3fb8aa3b
    s_mov_b32 s85, 0x3fb8aa3b
    s_mov_b32 s86, 2.0
    s_mov_b32 s87, 2.0
    s_mov_b32 s5, 0x3eb8aa3b
    s_mov_b32 s6, 0x41f00000
    v_mov_b32 v76, 0
    v_mov_b32 v77, 0
    v_mov_b32 v78, 0
    v_mov_b32 v79, 0
    v_mov_b32 v80, 0
    v_mov_b32 v81, 0
    v_mov_b32 v82, 0
    v_mov_b32 v83, 0
    v_mov_b32 v84, 0
    v_mov_b32 v85, 0
    v_mov_b32 v86, 0
    v_mov_b32 v87, 0
    v_mov_b32 v88, 0
    v_mov_b32 v89, 0
    v_mov_b32 v90, 0
    v_mov_b32 v91, 0
    v_mov_b32 v92, 0
    v_mov_b32 v93, 0
    v_mov_b32 v94, 0
    v_mov_b32 v95, 0
    v_mov_b32 v96, 0
    v_mov_b32 v97, 0
    v_mov_b32 v98, 0
    v_mov_b32 v99, 0
    v_mov_b32 v100, 0
    v_mov_b32 v101, 0
    v_mov_b32 v102, 0
    v_mov_b32 v103, 0
    v_mov_b32 v104, 0
    v_mov_b32 v105, 0
    v_mov_b32 v106, 0
    v_mov_b32 v107, 0
    v_mov_b32 v108, 0
    v_mov_b32 v109, 0
    v_mov_b32 v110, 0
    v_mov_b32 v111, 0
    v_mov_b32 v112, 0
    v_mov_b32 v113, 0
    v_mov_b32 v114, 0
    v_mov_b32 v115, 0
    v_mov_b32 v116, 0
    v_mov_b32 v117, 0
    v_mov_b32 v118, 0
    v_mov_b32 v119, 0
    v_mov_b32 v120, 0
    v_mov_b32 v121, 0
    v_mov_b32 v122, 0
    v_mov_b32 v123, 0
    v_mov_b32 v124, 0
    v_mov_b32 v125, 0
    v_mov_b32 v126, 0
    v_mov_b32 v127, 0
    v_mov_b32 v128, 0
    v_mov_b32 v129, 0
    v_mov_b32 v130, 0
    v_mov_b32 v131, 0
    v_mov_b32 v132, 0
    v_mov_b32 v133, 0
    v_mov_b32 v134, 0
    v_mov_b32 v135, 0
    v_mov_b32 v136, 0
    v_mov_b32 v137, 0
    v_mov_b32 v138, 0
    v_mov_b32 v139, 0
    v_mov_b32 v36, 0
    v_mov_b32 v37, 0
    v_mov_b32 v38, 0
    v_mov_b32 v39, 0
    v_mov_b32 v40, 0
    v_mov_b32 v41, 0
    v_mov_b32 v42, 0
    v_mov_b32 v43, 0
    v_mov_b32 v60, 0
    v_mov_b32 v61, 0
    v_mov_b32 v62, 0
    v_mov_b32 v63, 0
    v_mov_b32 v64, 0
    v_mov_b32 v65, 0
    v_mov_b32 v66, 0
    v_mov_b32 v67, 0
    v_mov_b32 v68, 0
    v_mov_b32 v69, 0
    v_mov_b32 v70, 0
    v_mov_b32 v71, 0
    v_mov_b32 v72, 0
    v_mov_b32 v73, 0
    v_mov_b32 v74, 0
    v_mov_b32 v75, 0
    s_mov_b32 s58, 3
    s_mov_b32 s48, 0
P1A_S0_LOOP:
    s_barrier
    s_waitcnt lgkmcnt(7)
    v_mfma_f32_32x32x16_bf16 v[76:91], v[60:63], v[36:39], v[76:91]
    ds_read_b128 v[28:31], v14
    ds_read_b64_tr_b16 v[44:45], v18 offset:0
    ds_read_b64_tr_b16 v[46:47], v18 offset:512
    s_waitcnt lgkmcnt(8)
    v_mfma_f32_32x32x16_bf16 v[92:107], v[64:67], v[36:39], v[92:107]
    ds_read_b64_tr_b16 v[48:49], v18 offset:8192
    ds_read_b64_tr_b16 v[50:51], v18 offset:8704
    s_waitcnt lgkmcnt(7)
    v_mfma_f32_32x32x16_bf16 v[76:91], v[68:71], v[40:43], v[76:91]
    ds_read_b128 v[32:35], v15
    ds_read_b64_tr_b16 v[52:53], v18 offset:2048
    ds_read_b64_tr_b16 v[54:55], v18 offset:2560
    s_waitcnt lgkmcnt(8)
    v_mfma_f32_32x32x16_bf16 v[92:107], v[72:75], v[40:43], v[92:107]
    ds_read_b64_tr_b16 v[56:57], v18 offset:10240
    ds_read_b64_tr_b16 v[58:59], v18 offset:10752
    s_cmp_eq_u32 s48, 3
    s_cbranch_scc1 P1A_PF
    s_cmp_eq_u32 s48, 1
    s_cbranch_scc1 P1A_G
P1A_BACK0:
    s_waitcnt lgkmcnt(7)
    v_mfma_f32_32x32x16_bf16 v[76:91], v[44:47], v[28:31], v[76:91]
    ds_read_b128 v[36:39], v16
    ds_read_b64_tr_b16 v[60:61], v18 offset:4096
    ds_read_b64_tr_b16 v[62:63], v18 offset:4608
    s_waitcnt lgkmcnt(8)
    v_mfma_f32_32x32x16_bf16 v[92:107], v[48:51], v[28:31], v[92:107]
    ds_read_b64_tr_b16 v[64:65], v18 offset:12288
    ds_read_b64_tr_b16 v[66:67], v18 offset:12800
    s_waitcnt lgkmcnt(7)
    v_mfma_f32_32x32x16_bf16 v[76:91], v[52:55], v[32:35], v[76:91]
    ds_read_b128 v[40:43], v17
    ds_read_b64_tr_b16 v[68:69], v18 offset:6144
    ds_read_b64_tr_b16 v[70:71], v18 offset:6656
    s_waitcnt lgkmcnt(8)
    v_mfma_f32_32x32x16_bf16 v[92:107], v[56:59], v[32:35], v[92:107]
    ds_read_b64_tr_b16 v[72:73], v18 offset:14336
    ds_read_b64_tr_b16 v[74:75], v18 offset:14848
    s_add_u32 s58, s58, 1
    s_mov_b32 s44, 32768
    s_cmp_eq_u32 s58, 5
    s_cselect_b32 s44, 4294836224, s44
    s_cselect_b32 s58, 0, s58
    v_add_u32 v14, s44, v14
    v_add_u32 v15, s44, v15
    v_add_u32 v16, s44, v16
    v_add_u32 v17, s44, v17
    v_add_u32 v18, s44, v18
    v_add_u32 v13, s44, v13
    s_add_u32 s48, s48, 1
    s_cmp_lt_u32 s48, 8
    s_cbranch_scc1 P1A_S0_LOOP
    s_waitcnt lgkmcnt(7)
    v_mfma_f32_32x32x16_bf16 v[76:91], v[60:63], v[36:39], v[76:91]
    s_waitcnt lgkmcnt(5)
    v_mfma_f32_32x32x16_bf16 v[92:107], v[64:67], v[36:39], v[92:107]
    s_waitcnt lgkmcnt(2)
    v_mfma_f32_32x32x16_bf16 v[76:91], v[68:71], v[40:43], v[76:91]
    s_waitcnt lgkmcnt(0)
    v_mfma_f32_32x32x16_bf16 v[92:107], v[72:75], v[40:43], v[92:107]
    v_mov_b32 v36, 0
    v_mov_b32 v37, 0
    v_mov_b32 v38, 0
    v_mov_b32 v39, 0
    v_mov_b32 v40, 0
    v_mov_b32 v41, 0
    v_mov_b32 v42, 0
    v_mov_b32 v43, 0
    s_lshl_b32 s7, s41, 1
    s_add_u32 s50, s7, s47
    s_lshl_b32 s51, s50, 17
    s_lshl_b32 s44, s43, 10
    s_add_u32 s51, s51, s44
    s_lshl_b32 s52, s51, 1
    s_xor_b32 s52, s52, 2097152
    s_add_u32 s52, s52, 2097152
    s_add_u32 s53, s51, 65536
    s_add_u32 s54, s52, 131072
    v_mov_b32 v2, 0
    global_load_dwordx2 v[150:151], v2, s[100:101] sc0 sc1
    v_cvt_pk_bf16_f32 v44, v92, v93
    v_cvt_pk_bf16_f32 v45, v94, v95
    v_cvt_pk_bf16_f32 v46, v96, v97
    v_cvt_pk_bf16_f32 v47, v98, v99
    v_cvt_pk_bf16_f32 v48, v100, v101
    v_cvt_pk_bf16_f32 v49, v102, v103
    v_cvt_pk_bf16_f32 v50, v104, v105
    v_cvt_pk_bf16_f32 v51, v106, v107
    buffer_store_dwordx4 v[44:47], v12, s[36:39], s52 offen sc0 sc1
    buffer_store_dwordx4 v[48:51], v12, s[36:39], s54 offen sc0 sc1
    v_mul_f32 v76, s5, v76
    v_mul_f32 v77, s5, v77
    v_mul_f32 v78, s5, v78
    v_mul_f32 v79, s5, v79
    v_mul_f32 v80, s5, v80
    v_mul_f32 v81, s5, v81
    v_mul_f32 v82, s5, v82
    v_mul_f32 v83, s5, v83
    v_mul_f32 v84, s5, v84
    v_mul_f32 v85, s5, v85
    v_mul_f32 v86, s5, v86
    v_mul_f32 v87, s5, v87
    v_mul_f32 v88, s5, v88
    v_mul_f32 v89, s5, v89
    v_mul_f32 v90, s5, v90
    v_mul_f32 v91, s5, v91
    v_cvt_pk_bf16_f32 v52, v76, v77
    v_cvt_pk_bf16_f32 v53, v78, v79
    v_cvt_pk_bf16_f32 v54, v80, v81
    v_cvt_pk_bf16_f32 v55, v82, v83
    v_cvt_pk_bf16_f32 v56, v84, v85
    v_cvt_pk_bf16_f32 v57, v86, v87
    v_cvt_pk_bf16_f32 v58, v88, v89
    v_cvt_pk_bf16_f32 v59, v90, v91
    buffer_store_dwordx4 v[52:55], v11, s[36:39], s51 offen sc0 sc1
    buffer_store_dwordx4 v[56:59], v11, s[36:39], s53 offen sc0 sc1
    s_cmp_eq_u32 s47, 0
    s_cbranch_scc1 P1A_H0
    s_mov_b32 s48, 0
P1A_S1h_LOOP:
    s_cmp_lg_u32 s48, 1
    s_cbranch_scc1 P1A_S1h_NW
    s_waitcnt vmcnt(0)
P1A_S1h_NW:
    s_barrier
    s_waitcnt lgkmcnt(3)
    v_mfma_f32_32x32x16_bf16 v[108:123], v[60:63], v[36:39], v[108:123]
    ds_read_b128 v[28:31], v14
    ds_read_b64_tr_b16 v[44:45], v18 offset:0
    ds_read_b64_tr_b16 v[46:47], v18 offset:512
    s_waitcnt lgkmcnt(3)
    v_mfma_f32_32x32x16_bf16 v[108:123], v[68:71], v[40:43], v[108:123]
    ds_read_b128 v[32:35], v15
    ds_read_b64_tr_b16 v[52:53], v18 offset:2048
    ds_read_b64_tr_b16 v[54:55], v18 offset:2560
    s_waitcnt lgkmcnt(3)
    v_mfma_f32_32x32x16_bf16 v[108:123], v[44:47], v[28:31], v[108:123]
    ds_read_b128 v[36:39], v16
    ds_read_b64_tr_b16 v[60:61], v18 offset:4096
    ds_read_b64_tr_b16 v[62:63], v18 offset:4608
    s_waitcnt lgkmcnt(3)
    v_mfma_f32_32x32x16_bf16 v[108:123], v[52:55], v[32:35], v[108:123]
    ds_read_b128 v[40:43], v17
    ds_read_b64_tr_b16 v[68:69], v18 offset:6144
    ds_read_b64_tr_b16 v[70:71], v18 offset:6656
    s_add_u32 s58, s58, 1
    s_mov_b32 s44, 32768
    s_cmp_eq_u32 s58, 5
    s_cselect_b32 s44, 4294836224, s44
    s_cselect_b32 s58, 0, s58
    v_add_u32 v14, s44, v14
    v_add_u32 v15, s44, v15
    v_add_u32 v16, s44, v16
    v_add_u32 v17, s44, v17
    v_add_u32 v18, s44, v18
    v_add_u32 v13, s44, v13
    s_add_u32 s48, s48, 1
    s_cmp_lt_u32 s48, 8
    s_cbranch_scc1 P1A_S1h_LOOP
    s_waitcnt lgkmcnt(3)
    v_mfma_f32_32x32x16_bf16 v[108:123], v[60:63], v[36:39], v[108:123]
    s_waitcnt lgkmcnt(0)
    v_mfma_f32_32x32x16_bf16 v[108:123], v[68:71], v[40:43], v[108:123]
    s_branch P1A_EPI
P1A_H0:
    s_mov_b32 s48, 0
P1A_S1_LOOP:
    s_cmp_lg_u32 s48, 1
    s_cbranch_scc1 P1A_S1_NW
    s_waitcnt vmcnt(0)
P1A_S1_NW:
    s_barrier
    s_waitcnt lgkmcnt(7)
    v_mfma_f32_32x32x16_bf16 v[108:123], v[60:63], v[36:39], v[108:123]
    ds_read_b128 v[28:31], v14
    ds_read_b64_tr_b16 v[44:45], v18 offset:0
    ds_read_b64_tr_b16 v[46:47], v18 offset:512
    s_waitcnt lgkmcnt(8)
    v_mfma_f32_32x32x16_bf16 v[124:139], v[64:67], v[36:39], v[124:139]
    ds_read_b64_tr_b16 v[48:49], v13 offset:0
    ds_read_b64_tr_b16 v[50:51], v13 offset:256
    s_waitcnt lgkmcnt(7)
    v_mfma_f32_32x32x16_bf16 v[108:123], v[68:71], v[40:43], v[108:123]
    ds_read_b128 v[32:35], v15
    ds_read_b64_tr_b16 v[52:53], v18 offset:2048
    ds_read_b64_tr_b16 v[54:55], v18 offset:2560
    s_waitcnt lgkmcnt(8)
    v_mfma_f32_32x32x16_bf16 v[124:139], v[72:75], v[40:43], v[124:139]
    ds_read_b64_tr_b16 v[56:57], v13 offset:1024
    ds_read_b64_tr_b16 v[58:59], v13 offset:1280
    s_cmp_eq_u32 s48, 1
    s_cbranch_scc1 P1A_F1
P1A_BACK1:
    s_waitcnt lgkmcnt(7)
    v_mfma_f32_32x32x16_bf16 v[108:123], v[44:47], v[28:31], v[108:123]
    ds_read_b128 v[36:39], v16
    ds_read_b64_tr_b16 v[60:61], v18 offset:4096
    ds_read_b64_tr_b16 v[62:63], v18 offset:4608
    s_waitcnt lgkmcnt(8)
    v_mfma_f32_32x32x16_bf16 v[124:139], v[48:51], v[28:31], v[124:139]
    ds_read_b64_tr_b16 v[64:65], v13 offset:2048
    ds_read_b64_tr_b16 v[66:67], v13 offset:2304
    s_waitcnt lgkmcnt(7)
    v_mfma_f32_32x32x16_bf16 v[108:123], v[52:55], v[32:35], v[108:123]
    ds_read_b128 v[40:43], v17
    ds_read_b64_tr_b16 v[68:69], v18 offset:6144
    ds_read_b64_tr_b16 v[70:71], v18 offset:6656
    s_waitcnt lgkmcnt(8)
    v_mfma_f32_32x32x16_bf16 v[124:139], v[56:59], v[32:35], v[124:139]
    ds_read_b64_tr_b16 v[72:73], v13 offset:3072
    ds_read_b64_tr_b16 v[74:75], v13 offset:3328
    s_add_u32 s58, s58, 1
    s_mov_b32 s44, 32768
    s_cmp_eq_u32 s58, 5
    s_cselect_b32 s44, 4294836224, s44
    s_cselect_b32 s58, 0, s58
    v_add_u32 v14, s44, v14
    v_add_u32 v15, s44, v15
    v_add_u32 v16, s44, v16
    v_add_u32 v17, s44, v17
    v_add_u32 v18, s44, v18
    v_add_u32 v13, s44, v13
    s_add_u32 s48, s48, 1
    s_cmp_lt_u32 s48, 8
    s_cbranch_scc1 P1A_S1_LOOP
    s_waitcnt lgkmcnt(7)
    v_mfma_f32_32x32x16_bf16 v[108:123], v[60:63], v[36:39], v[108:123]
    s_waitcnt lgkmcnt(5)
    v_mfma_f32_32x32x16_bf16 v[124:139], v[64:67], v[36:39], v[124:139]
    s_waitcnt lgkmcnt(2)
    v_mfma_f32_32x32x16_bf16 v[108:123], v[68:71], v[40:43], v[108:123]
    s_waitcnt lgkmcnt(0)
    v_mfma_f32_32x32x16_bf16 v[124:139], v[72:75], v[40:43], v[124:139]
    s_branch P1A_EPI
P1A_F1:
    s_cmp_lg_u32 s40, 0
    s_cbranch_scc1 P1A_F1C
    s_mov_b32 s51, 0x40000
P1A_F1A:
    v_readfirstlane_b32 s50, v150
    v_mov_b32 v2, 0
    s_lshl_b32 s46, s2, 6
    s_add_u32 s46, s46, 19988480
    s_nop 1
    s_cmp_lg_u32 s50, 0
    s_cbranch_scc1 P1A_F1B
    s_cmp_eq_u32 s51, 0
    s_cbranch_scc1 P1A_F1B
    s_sub_u32 s51, s51, 1
    global_load_dwordx2 v[150:151], v2, s[100:101] sc0 sc1
    s_waitcnt vmcnt(0)
    s_branch P1A_F1A
P1A_F1B:
    s_mov_b64 exec, 1
    buffer_store_dwordx2 v[150:151], v2, s[36:39], s46 offen sc0 sc1
    s_mov_b64 exec, -1
P1A_F1C:
    s_branch P1A_BACK1
P1A_G:
    s_waitcnt vmcnt(0)
    v_mov_b32 v23, 0
    v_mov_b32 v24, 0
    v_dot2_f32_bf16 v23, v150, v154, v23
    v_dot2_f32_bf16 v24, v151, v155, v24
    v_dot2_f32_bf16 v23, v152, v156, v23
    v_dot2_f32_bf16 v24, v153, v157, v24
    s_nop 2
    v_add_f32 v23, v23, v24
    s_nop 1
    v_add_f32_dpp v23, v23, v23 quad_perm:[1,0,3,2] row_mask:0xf bank_mask:0xf
    s_nop 1
    v_add_f32_dpp v23, v23, v23 quad_perm:[2,3,0,1] row_mask:0xf bank_mask:0xf
    s_nop 1
    v_add_f32_dpp v23, v23, v23 row_half_mirror row_mask:0xf bank_mask:0xf
    s_nop 1
    v_add_f32_dpp v23, v23, v23 row_mirror row_mask:0xf bank_mask:0xf
    s_nop 0
    v_readlane_b32 s50, v23, 0
    v_readlane_b32 s51, v23, 16
    v_readlane_b32 s52, v23, 32
    v_readlane_b32 s53, v23, 48
    s_mov_b32 s45, s94
    s_nop 0
    v_mov_b32 v23, s50
    v_add_f32 v23, s51, v23
    v_add_f32 v23, s52, v23
    v_add_f32 v23, s53, v23
    v_mul_f32 v23, s84, v23
    v_exp_f32 v23, -v23
    s_lshl_b32 s45, s45, 2
    v_add_f32 v23, 1.0, v23
    v_rcp_f32 v23, v23
    s_add_u32 s45, s45, 19922944
    v_mov_b32 v24, 0
    s_mov_b64 exec, 1
    buffer_store_dword v23, v24, s[36:39], s45 offen sc0 sc1
    s_mov_b64 exec, -1
    s_branch P1A_BACK0
P1A_PF:
    s_cmp_ge_u32 s40, 2
    s_cbranch_scc1 P1A_BACK0
    s_cmp_eq_u32 s40, 0
    s_cselect_b32 s45, s61, s62
    s_bfe_u32 s46, s2, 0x30003
    s_mul_i32 s46, s46, 229376
    s_add_u32 s45, s45, s46
    v_mul_u32_u24 v2, 3584, v1
    buffer_load_dword v27, v2, s[20:23], s45 offen
    s_branch P1A_BACK0
P1A_EPI:
    v_mfma_f32_32x32x16_bf16 v[108:123], v[140:143], v[146:149], v[108:123]
    s_mul_i32 s46, s43, 147456
    s_add_u32 s46, s46, 6324224
    s_lshl_b32 s45, s47, 11
    s_add_u32 s45, s45, s46
    v_mfma_f32_32x32x16_bf16 v[124:139], v[142:145], v[146:149], v[124:139]
    s_lshl_b32 s7, s61, 5
    s_add_u32 s7, s7, s45
    s_add_u32 s76, s7, 0
    s_lshl_b32 s7, s61, 5
    s_add_u32 s7, s7, s45
    s_add_u32 s77, s7, 1024
    s_lshl_b32 s7, s62, 5
    s_add_u32 s7, s7, s46
    s_add_u32 s78, s7, 0
    s_lshl_b32 s7, s62, 5
    s_add_u32 s7, s7, s46
    s_add_u32 s79, s7, 1024
    s_mov_b32 s56, s47
    v_pk_mul_f32 v[76:77], v[108:109], s[84:85]
    v_pk_mul_f32 v[78:79], v[110:111], s[84:85]
    v_pk_mul_f32 v[80:81], v[112:113], s[84:85]
    v_pk_mul_f32 v[82:83], v[114:115], s[84:85]
    v_min_f32 v76, s6, v76
    v_min_f32 v77, s6, v77
    v_min_f32 v78, s6, v78
    v_min_f32 v79, s6, v79
    v_min_f32 v80, s6, v80
    v_min_f32 v81, s6, v81
    v_min_f32 v82, s6, v82
    v_min_f32 v83, s6, v83
    v_exp_f32 v76, v76
    v_exp_f32 v77, v77
    v_exp_f32 v78, v78
    v_exp_f32 v79, v79
    v_exp_f32 v80, v80
    v_exp_f32 v81, v81
    v_exp_f32 v82, v82
    v_exp_f32 v83, v83
    v_pk_add_f32 v[84:85], v[76:77], s[86:87]
    v_pk_add_f32 v[86:87], v[78:79], s[86:87]
    v_pk_add_f32 v[88:89], v[80:81], s[86:87]
    v_pk_add_f32 v[90:91], v[82:83], s[86:87]
    v_pk_mul_f32 v[84:85], v[76:77], v[84:85]
    v_pk_mul_f32 v[86:87], v[78:79], v[86:87]
    v_pk_mul_f32 v[88:89], v[80:81], v[88:89]
    v_pk_mul_f32 v[90:91], v[82:83], v[90:91]
    v_pk_add_f32 v[44:45], v[84:85], s[86:87]
    v_pk_add_f32 v[46:47], v[86:87], s[86:87]
    v_pk_add_f32 v[48:49], v[88:89], s[86:87]
    v_pk_add_f32 v[50:51], v[90:91], s[86:87]
    v_rcp_f32 v44, v44
    v_rcp_f32 v45, v45
    v_rcp_f32 v46, v46
    v_rcp_f32 v47, v47
    v_rcp_f32 v48, v48
    v_rcp_f32 v49, v49
    v_rcp_f32 v50, v50
    v_rcp_f32 v51, v51
    v_pk_mul_f32 v[84:85], v[84:85], v[44:45]
    v_pk_mul_f32 v[86:87], v[86:87], v[46:47]
    v_pk_mul_f32 v[88:89], v[88:89], v[48:49]
    v_pk_mul_f32 v[90:91], v[90:91], v[50:51]
    v_pk_mul_f32 v[76:77], v[108:109], v[84:85]
    v_pk_mul_f32 v[78:79], v[110:111], v[86:87]
    v_pk_mul_f32 v[80:81], v[112:113], v[88:89]
    v_pk_mul_f32 v[82:83], v[114:115], v[90:91]
    v_cvt_pk_bf16_f32 v152, v76, v77
    v_cvt_pk_bf16_f32 v153, v78, v79
    v_cvt_pk_bf16_f32 v154, v80, v81
    v_cvt_pk_bf16_f32 v155, v82, v83
    v_pk_mul_f32 v[76:77], v[116:117], s[84:85]
    v_pk_mul_f32 v[78:79], v[118:119], s[84:85]
    v_pk_mul_f32 v[80:81], v[120:121], s[84:85]
    v_pk_mul_f32 v[82:83], v[122:123], s[84:85]
    v_min_f32 v76, s6, v76
    v_min_f32 v77, s6, v77
    v_min_f32 v78, s6, v78
    v_min_f32 v79, s6, v79
    v_min_f32 v80, s6, v80
    v_min_f32 v81, s6, v81
    v_min_f32 v82, s6, v82
    v_min_f32 v83, s6, v83
    v_exp_f32 v76, v76
    v_exp_f32 v77, v77
    v_exp_f32 v78, v78
    v_exp_f32 v79, v79
    v_exp_f32 v80, v80
    v_exp_f32 v81, v81
    v_exp_f32 v82, v82
    v_exp_f32 v83, v83
    v_pk_add_f32 v[84:85], v[76:77], s[86:87]
    v_pk_add_f32 v[86:87], v[78:79], s[86:87]
    v_pk_add_f32 v[88:89], v[80:81], s[86:87]
    v_pk_add_f32 v[90:91], v[82:83], s[86:87]
    v_pk_mul_f32 v[84:85], v[76:77], v[84:85]
    v_pk_mul_f32 v[86:87], v[78:79], v[86:87]
    v_pk_mul_f32 v[88:89], v[80:81], v[88:89]
    v_pk_mul_f32 v[90:91], v[82:83], v[90:91]
    v_pk_add_f32 v[44:45], v[84:85], s[86:87]
    v_pk_add_f32 v[46:47], v[86:87], s[86:87]
    v_pk_add_f32 v[48:49], v[88:89], s[86:87]
    v_pk_add_f32 v[50:51], v[90:91], s[86:87]
    v_rcp_f32 v44, v44
    v_rcp_f32 v45, v45
    v_rcp_f32 v46, v46
    v_rcp_f32 v47, v47
    v_rcp_f32 v48, v48
    v_rcp_f32 v49, v49
    v_rcp_f32 v50, v50
    v_rcp_f32 v51, v51
    v_pk_mul_f32 v[84:85], v[84:85], v[44:45]
    v_pk_mul_f32 v[86:87], v[86:87], v[46:47]
    v_pk_mul_f32 v[88:89], v[88:89], v[48:49]
    v_pk_mul_f32 v[90:91], v[90:91], v[50:51]
    v_pk_mul_f32 v[76:77], v[116:117], v[84:85]
    v_pk_mul_f32 v[78:79], v[118:119], v[86:87]
    v_pk_mul_f32 v[80:81], v[120:121], v[88:89]
    v_pk_mul_f32 v[82:83], v[122:123], v[90:91]
    v_cvt_pk_bf16_f32 v156, v76, v77
    v_cvt_pk_bf16_f32 v157, v78, v79
    v_cvt_pk_bf16_f32 v158, v80, v81
    v_cvt_pk_bf16_f32 v159, v82, v83
    s_cmp_eq_u32 s47, 1
    s_cbranch_scc1 P1A_EDONE
    v_pk_mul_f32 v[76:77], v[124:125], s[84:85]
    v_pk_mul_f32 v[78:79], v[126:127], s[84:85]
    v_pk_mul_f32 v[80:81], v[128:129], s[84:85]
    v_pk_mul_f32 v[82:83], v[130:131], s[84:85]
    v_min_f32 v76, s6, v76
    v_min_f32 v77, s6, v77
    v_min_f32 v78, s6, v78
    v_min_f32 v79, s6, v79
    v_min_f32 v80, s6, v80
    v_min_f32 v81, s6, v81
    v_min_f32 v82, s6, v82
    v_min_f32 v83, s6, v83
    v_exp_f32 v76, v76
    v_exp_f32 v77, v77
    v_exp_f32 v78, v78
    v_exp_f32 v79, v79
    v_exp_f32 v80, v80
    v_exp_f32 v81, v81
    v_exp_f32 v82, v82
    v_exp_f32 v83, v83
    v_pk_add_f32 v[84:85], v[76:77], s[86:87]
    v_pk_add_f32 v[86:87], v[78:79], s[86:87]
    v_pk_add_f32 v[88:89], v[80:81], s[86:87]
    v_pk_add_f32 v[90:91], v[82:83], s[86:87]
    v_pk_mul_f32 v[84:85], v[76:77], v[84:85]
    v_pk_mul_f32 v[86:87], v[78:79], v[86:87]
    v_pk_mul_f32 v[88:89], v[80:81], v[88:89]
    v_pk_mul_f32 v[90:91], v[82:83], v[90:91]
    v_pk_add_f32 v[44:45], v[84:85], s[86:87]
    v_pk_add_f32 v[46:47], v[86:87], s[86:87]
    v_pk_add_f32 v[48:49], v[88:89], s[86:87]
    v_pk_add_f32 v[50:51], v[90:91], s[86:87]
    v_rcp_f32 v44, v44
    v_rcp_f32 v45, v45
    v_rcp_f32 v46, v46
    v_rcp_f32 v47, v47
    v_rcp_f32 v48, v48
    v_rcp_f32 v49, v49
    v_rcp_f32 v50, v50
    v_rcp_f32 v51, v51
    v_pk_mul_f32 v[84:85], v[84:85], v[44:45]
    v_pk_mul_f32 v[86:87], v[86:87], v[46:47]
    v_pk_mul_f32 v[88:89], v[88:89], v[48:49]
    v_pk_mul_f32 v[90:91], v[90:91], v[50:51]
    v_pk_mul_f32 v[76:77], v[124:125], v[84:85]
    v_pk_mul_f32 v[78:79], v[126:127], v[86:87]
    v_pk_mul_f32 v[80:81], v[128:129], v[88:89]
    v_pk_mul_f32 v[82:83], v[130:131], v[90:91]
    v_cvt_pk_bf16_f32 v160, v76, v77
    v_cvt_pk_bf16_f32 v161, v78, v79
    v_cvt_pk_bf16_f32 v162, v80, v81
    v_cvt_pk_bf16_f32 v163, v82, v83
    v_pk_mul_f32 v[76:77], v[132:133], s[84:85]
    v_pk_mul_f32 v[78:79], v[134:135], s[84:85]
    v_pk_mul_f32 v[80:81], v[136:137], s[84:85]
    v_pk_mul_f32 v[82:83], v[138:139], s[84:85]
    v_min_f32 v76, s6, v76
    v_min_f32 v77, s6, v77
    v_min_f32 v78, s6, v78
    v_min_f32 v79, s6, v79
    v_min_f32 v80, s6, v80
    v_min_f32 v81, s6, v81
    v_min_f32 v82, s6, v82
    v_min_f32 v83, s6, v83
    v_exp_f32 v76, v76
    v_exp_f32 v77, v77
    v_exp_f32 v78, v78
    v_exp_f32 v79, v79
    v_exp_f32 v80, v80
    v_exp_f32 v81, v81
    v_exp_f32 v82, v82
    v_exp_f32 v83, v83
    v_pk_add_f32 v[84:85], v[76:77], s[86:87]
    v_pk_add_f32 v[86:87], v[78:79], s[86:87]
    v_pk_add_f32 v[88:89], v[80:81], s[86:87]
    v_pk_add_f32 v[90:91], v[82:83], s[86:87]
    v_pk_mul_f32 v[84:85], v[76:77], v[84:85]
    v_pk_mul_f32 v[86:87], v[78:79], v[86:87]
    v_pk_mul_f32 v[88:89], v[80:81], v[88:89]
    v_pk_mul_f32 v[90:91], v[82:83], v[90:91]
    v_pk_add_f32 v[44:45], v[84:85], s[86:87]
    v_pk_add_f32 v[46:47], v[86:87], s[86:87]
    v_pk_add_f32 v[48:49], v[88:89], s[86:87]
    v_pk_add_f32 v[50:51], v[90:91], s[86:87]
    v_rcp_f32 v44, v44
    v_rcp_f32 v45, v45
    v_rcp_f32 v46, v46
    v_rcp_f32 v47, v47
    v_rcp_f32 v48, v48
    v_rcp_f32 v49, v49
    v_rcp_f32 v50, v50
    v_rcp_f32 v51, v51
    v_pk_mul_f32 v[84:85], v[84:85], v[44:45]
    v_pk_mul_f32 v[86:87], v[86:87], v[46:47]
    v_pk_mul_f32 v[88:89], v[88:89], v[48:49]
    v_pk_mul_f32 v[90:91], v[90:91], v[50:51]
    v_pk_mul_f32 v[76:77], v[132:133], v[84:85]
    v_pk_mul_f32 v[78:79], v[134:135], v[86:87]
    v_pk_mul_f32 v[80:81], v[136:137], v[88:89]
    v_pk_mul_f32 v[82:83], v[138:139], v[90:91]
    v_cvt_pk_bf16_f32 v164, v76, v77
    v_cvt_pk_bf16_f32 v165, v78, v79
    v_cvt_pk_bf16_f32 v166, v80, v81
    v_cvt_pk_bf16_f32 v167, v82, v83
P1A_EDONE:
    s_branch P2_ATT
P1_B:
    s_lshl_b32 s59, s41, 7
    s_add_u32 s59, s59, 2048
    s_lshl_b32 s61, s41, 8
    s_add_u32 s62, s61, 128
    s_cmp_ge_u32 s40, 8
    s_cbranch_scc0 P1B_COMP
    s_sub_u32 s63, s40, 8
    s_and_b32 s57, s2, 7
    s_bfe_u32 s44, s2, 0x30003
    s_and_b32 s44, s44, 1
    s_add_u32 s57, s57, s44
    s_and_b32 s57, s57, 7
    s_mov_b32 s58, 98304
    s_lshl_b32 s53, s42, 2
    s_add_u32 s53, s53, s63
    s_lshl_b32 s53, s53, 15
    s_mul_i32 s45, s63, 49152
    s_mul_i32 s46, s63, 57344
    s_add_u32 s49, s59, s45
    s_add_u32 s51, s61, s46
    s_add_u32 s52, s62, s46
    s_mov_b32 s48, 0
    s_waitcnt lgkmcnt(0)
P1B_LD0:
    s_lshl_b32 s97, s57, 7
    s_add_u32 s97, s97, s53
    s_mul_i32 s98, s57, 196608
    s_lshl_b32 s44, s63, 10
    s_add_u32 s56, s58, s44
    s_add_u32 s55, s56, s44
    s_lshl_b32 s44, s44, 1
    s_add_u32 s54, s55, s44
    s_add_u32 m0, s54, 0
    s_add_u32 s7, s97, 0
    buffer_load_dwordx4 v6, s[8:11], s7 offen lds
    s_add_u32 m0, s54, 1024
    s_add_u32 s7, s97, 8192
    buffer_load_dwordx4 v7, s[8:11], s7 offen lds
    s_add_u32 m0, s54, 2048
    s_add_u32 s7, s97, 16384
    buffer_load_dwordx4 v6, s[8:11], s7 offen lds
    s_add_u32 m0, s54, 3072
    s_add_u32 s7, s97, 24576
    buffer_load_dwordx4 v7, s[8:11], s7 offen lds
    s_add_u32 m0, s55, 16384
    s_add_u32 s7, s98, s49
    buffer_load_dwordx4 v8, s[12:15], s7 offen lds
    s_add_u32 m0, s55, 17408
    s_add_u32 s7, s98, s49
    s_add_u32 s7, s7, 24576
    buffer_load_dwordx4 v8, s[12:15], s7 offen lds
    s_add_u32 s57, s57, 1
    s_and_b32 s57, s57, 7
    s_add_u32 s58, s58, 32768
    s_cmp_eq_u32 s58, 163840
    s_cselect_b32 s58, 0, s58
    s_add_u32 s48, s48, 1
    s_cmp_lt_u32 s48, 2
    s_cbranch_scc1 P1B_LD0
    s_waitcnt vmcnt(6)
    s_barrier
    s_cmp_lt_u32 s48, 8
    s_cbranch_scc1 P1B_LD0
P1B_LD1:
    s_lshl_b32 s97, s57, 7
    s_add_u32 s97, s97, s53
    s_mul_i32 s98, s57, 229376
    s_lshl_b32 s44, s63, 10
    s_add_u32 s56, s58, s44
    s_add_u32 s55, s56, s44
    s_lshl_b32 s44, s44, 1
    s_add_u32 s54, s55, s44
    s_add_u32 m0, s54, 0
    s_add_u32 s7, s97, 0
    buffer_load_dwordx4 v6, s[8:11], s7 offen lds
    s_add_u32 m0, s54, 1024
    s_add_u32 s7, s97, 8192
    buffer_load_dwordx4 v7, s[8:11], s7 offen lds
    s_add_u32 m0, s54, 2048
    s_add_u32 s7, s97, 16384
    buffer_load_dwordx4 v6, s[8:11], s7 offen lds
    s_add_u32 m0, s54, 3072
    s_add_u32 s7, s97, 24576
    buffer_load_dwordx4 v7, s[8:11], s7 offen lds
    s_add_u32 m0, s55, 16384
    s_add_u32 s7, s98, s51
    buffer_load_dwordx4 v9, s[20:23], s7 offen lds
    s_add_u32 m0, s55, 17408
    s_add_u32 s7, s98, s51
    s_add_u32 s7, s7, 28672
    buffer_load_dwordx4 v9, s[20:23], s7 offen lds
    s_add_u32 m0, s55, 24576
    s_add_u32 s7, s98, s52
    buffer_load_dwordx4 v9, s[20:23], s7 offen lds
    s_add_u32 m0, s55, 25600
    s_add_u32 s7, s98, s52
    s_add_u32 s7, s7, 28672
    buffer_load_dwordx4 v9, s[20:23], s7 offen lds
    s_add_u32 s57, s57, 1
    s_and_b32 s57, s57, 7
    s_add_u32 s58, s58, 32768
    s_cmp_eq_u32 s58, 163840
    s_cselect_b32 s58, 0, s58
    s_add_u32 s48, s48, 1
    s_waitcnt vmcnt(6)
    s_barrier
    s_cmp_lt_u32 s48, 16
    s_cbranch_scc1 P1B_LD1
    s_mov_b32 s48, 0
    s_branch P2_SHADOW
P1B_COMP:
    s_waitcnt lgkmcnt(0)
    s_getpc_b64 s[82:83]
PFC_p1B:
    v_lshlrev_b32 v25, 7, v0
    v_min_u32 v26, MK_END-PFC_p1B-4, v25
    global_load_dword v27, v26, s[82:83]
    s_mov_b32 s26, 3584
    s_mov_b32 s27, 0x00020000
    s_mov_b32 s34, 1024
    s_mov_b32 s35, 0x00020000
    s_lshl_b32 s44, s96, 3
    s_add_u32 s44, s44, s40
    s_lshl_b32 s44, s44, 5
    s_add_u32 s44, s44, s95
    s_lshl_b32 s44, s44, 10
    s_add_u32 s97, s44, 20971520
    v_mov_b32 v140, 0
    v_mov_b32 v141, 0
    v_mov_b32 v142, 0
    v_mov_b32 v143, 0
    v_mov_b32 v144, 0
    v_mov_b32 v145, 0
    s_lshl_b32 s94, s42, 4
    s_add_u32 s94, s94, s41
    s_lshl_b32 s94, s94, 3
    s_add_u32 s94, s94, s40
    s_add_u32 s94, s94, 64
    s_lshl_b32 s45, s94, 10
    buffer_load_dwordx4 v[150:153], v11, s[8:11], s45 offen
    buffer_load_dwordx4 v[154:157], v11, s[32:35], 0 offen
    v_and_b32 v2, 31, v1
    v_lshlrev_b32 v2, 1, v2
    s_lshl_b32 s45, s47, 6
    s_add_u32 s7, s61, s45
    buffer_load_ushort v140, v2, s[24:27], s7 offen
    s_add_u32 s7, s62, s45
    buffer_load_ushort v142, v2, s[24:27], s7 offen
    v_and_b32 v2, 31, v1
    v_lshrrev_b32 v3, 5, v1
    v_bfe_u32 v4, v2, 1, 3
    v_xor_b32 v4, v4, v3
    v_lshlrev_b32 v5, 7, v2
    s_and_b32 s44, s40, 3
    s_lshl_b32 s44, s44, 12
    s_add_u32 s44, s44, 98304
    v_add_u32 v5, s44, v5
    v_lshl_add_u32 v5, v4, 4, v5
    v_mov_b32 v14, v5
    v_xor_b32 v15, 32, v14
    v_xor_b32 v16, 64, v14
    v_xor_b32 v17, 96, v14
    v_bfe_u32 v2, v1, 2, 2
    v_and_b32 v4, 3, v1
    v_bfe_u32 v5, v1, 4, 1
    v_lshlrev_b32 v18, 10, v3
    v_lshl_add_u32 v18, v2, 7, v18
    v_lshl_add_u32 v18, v5, 5, v18
    v_lshl_add_u32 v18, v4, 3, v18
    v_lshrrev_b32 v25, 1, v2
    v_lshl_add_u32 v18, v25, 6, v18
    v_xor_b32 v18, s45, v18
    v_add_u32 v18, 114688, v18
    v_and_b32 v26, 15, v1
    v_lshlrev_b32 v12, 4, v26
    v_lshl_add_u32 v12, v3, 8, v12
    v_lshl_add_u32 v12, v5, 17, v12
    v_add_u32 v12, 1024, v12
    s_lshl_b32 s98, s40, 11
    v_cmp_gt_u32 vcc, 32, v1
    v_mov_b32 v147, 0
    v_mov_b32 v148, 0
    v_mov_b32 v149, 0
    v_mov_b32 v2, 0x3f80
    v_cndmask_b32 v146, 0, v2, vcc
    s_mov_b32 s84, 0x3fb8aa3b
    s_mov_b32 s85, 0x3fb8aa3b
    s_mov_b32 s86, 2.0
    s_mov_b32 s87, 2.0
    s_mov_b32 s5, 0x3eb8aa3b
    s_mov_b32 s6, 0x41f00000
    v_mov_b32 v76, 0
    v_mov_b32 v77, 0
    v_mov_b32 v78, 0
    v_mov_b32 v79, 0
    v_mov_b32 v80, 0
    v_mov_b32 v81, 0
    v_mov_b32 v82, 0
    v_mov_b32 v83, 0
    v_mov_b32 v84, 0
    v_mov_b32 v85, 0
    v_mov_b32 v86, 0
    v_mov_b32 v87, 0
    v_mov_b32 v88, 0
    v_mov_b32 v89, 0
    v_mov_b32 v90, 0
    v_mov_b32 v91, 0
    v_mov_b32 v92, 0
    v_mov_b32 v93, 0
    v_mov_b32 v94, 0
    v_mov_b32 v95, 0
    v_mov_b32 v96, 0
    v_mov_b32 v97, 0
    v_mov_b32 v98, 0
    v_mov_b32 v99, 0
    v_mov_b32 v100, 0
    v_mov_b32 v101, 0
    v_mov_b32 v102, 0
    v_mov_b32 v103, 0
    v_mov_b32 v104, 0
    v_mov_b32 v105, 0
    v_mov_b32 v106, 0
    v_mov_b32 v107, 0
    v_mov_b32 v108, 0
    v_mov_b32 v109, 0
    v_mov_b32 v110, 0
    v_mov_b32 v111, 0
    v_mov_b32 v112, 0
    v_mov_b32 v113, 0
    v_mov_b32 v114, 0
    v_mov_b32 v115, 0
    v_mov_b32 v116, 0
    v_mov_b32 v117, 0
    v_mov_b32 v118, 0
    v_mov_b32 v119, 0
    v_mov_b32 v120, 0
    v_mov_b32 v121, 0
    v_mov_b32 v122, 0
    v_mov_b32 v123, 0
    v_mov_b32 v124, 0
    v_mov_b32 v125, 0
    v_mov_b32 v126, 0
    v_mov_b32 v127, 0
    v_mov_b32 v128, 0
    v_mov_b32 v129, 0
    v_mov_b32 v130, 0
    v_mov_b32 v131, 0
    v_mov_b32 v132, 0
    v_mov_b32 v133, 0
    v_mov_b32 v134, 0
    v_mov_b32 v135, 0
    v_mov_b32 v136, 0
    v_mov_b32 v137, 0
    v_mov_b32 v138, 0
    v_mov_b32 v139, 0
    v_mov_b32 v36, 0
    v_mov_b32 v37, 0
    v_mov_b32 v38, 0
    v_mov_b32 v39, 0
    v_mov_b32 v40, 0
    v_mov_b32 v41, 0
    v_mov_b32 v42, 0
    v_mov_b32 v43, 0
    v_mov_b32 v60, 0
    v_mov_b32 v61, 0
    v_mov_b32 v62, 0
    v_mov_b32 v63, 0
    v_mov_b32 v64, 0
    v_mov_b32 v65, 0
    v_mov_b32 v66, 0
    v_mov_b32 v67, 0
    v_mov_b32 v68, 0
    v_mov_b32 v69, 0
    v_mov_b32 v70, 0
    v_mov_b32 v71, 0
    v_mov_b32 v72, 0
    v_mov_b32 v73, 0
    v_mov_b32 v74, 0
    v_mov_b32 v75, 0
    s_mov_b32 s58, 3
    s_mov_b32 s48, 0
P1B_S0_LOOP:
    s_barrier
    s_waitcnt lgkmcnt(3)
    v_mfma_f32_32x32x16_bf16 v[76:91], v[36:39], v[60:63], v[76:91]
    ds_read_b128 v[28:31], v14
    ds_read_b64_tr_b16 v[44:45], v18 offset:0
    ds_read_b64_tr_b16 v[46:47], v18 offset:512
    s_waitcnt lgkmcnt(3)
    v_mfma_f32_32x32x16_bf16 v[76:91], v[40:43], v[68:71], v[76:91]
    ds_read_b128 v[32:35], v15
    ds_read_b64_tr_b16 v[52:53], v18 offset:2048
    ds_read_b64_tr_b16 v[54:55], v18 offset:2560
    s_cmp_eq_u32 s48, 3
    s_cbranch_scc1 P1B_PF
    s_cmp_eq_u32 s48, 1
    s_cbranch_scc1 P1B_G
P1B_BACK0:
    s_waitcnt lgkmcnt(3)
    v_mfma_f32_32x32x16_bf16 v[76:91], v[28:31], v[44:47], v[76:91]
    ds_read_b128 v[36:39], v16
    ds_read_b64_tr_b16 v[60:61], v18 offset:4096
    ds_read_b64_tr_b16 v[62:63], v18 offset:4608
    s_waitcnt lgkmcnt(3)
    v_mfma_f32_32x32x16_bf16 v[76:91], v[32:35], v[52:55], v[76:91]
    ds_read_b128 v[40:43], v17
    ds_read_b64_tr_b16 v[68:69], v18 offset:6144
    ds_read_b64_tr_b16 v[70:71], v18 offset:6656
    s_add_u32 s58, s58, 1
    s_mov_b32 s44, 32768
    s_cmp_eq_u32 s58, 5
    s_cselect_b32 s44, 4294836224, s44
    s_cselect_b32 s58, 0, s58
    v_add_u32 v14, s44, v14
    v_add_u32 v15, s44, v15
    v_add_u32 v16, s44, v16
    v_add_u32 v17, s44, v17
    v_add_u32 v18, s44, v18
    s_add_u32 s48, s48, 1
    s_cmp_lt_u32 s48, 8
    s_cbranch_scc1 P1B_S0_LOOP
    s_waitcnt lgkmcnt(3)
    v_mfma_f32_32x32x16_bf16 v[76:91], v[36:39], v[60:63], v[76:91]
    s_waitcnt lgkmcnt(0)
    v_mfma_f32_32x32x16_bf16 v[76:91], v[40:43], v[68:71], v[76:91]
    v_mov_b32 v36, 0
    v_mov_b32 v37, 0
    v_mov_b32 v38, 0
    v_mov_b32 v39, 0
    v_mov_b32 v40, 0
    v_mov_b32 v41, 0
    v_mov_b32 v42, 0
    v_mov_b32 v43, 0
    s_lshl_b32 s7, s41, 1
    s_add_u32 s50, s7, s47
    s_lshl_b32 s51, s50, 17
    s_lshl_b32 s44, s43, 10
    s_add_u32 s51, s51, s44
    s_lshl_b32 s52, s51, 1
    s_add_u32 s52, s52, 2097152
    s_add_u32 s53, s51, 65536
    s_add_u32 s54, s52, 131072
    v_mov_b32 v2, 0
    global_load_dwordx2 v[150:151], v2, s[100:101] sc0 sc1
    v_cvt_pk_bf16_f32 v52, v76, v77
    v_cvt_pk_bf16_f32 v53, v78, v79
    v_cvt_pk_bf16_f32 v54, v80, v81
    v_cvt_pk_bf16_f32 v55, v82, v83
    v_cvt_pk_bf16_f32 v56, v84, v85
    v_cvt_pk_bf16_f32 v57, v86, v87
    v_cvt_pk_bf16_f32 v58, v88, v89
    v_cvt_pk_bf16_f32 v59, v90, v91
    buffer_store_dwordx4 v[52:55], v12, s[36:39], s52 offen sc0 sc1
    buffer_store_dwordx4 v[56:59], v12, s[36:39], s52 offen offset:512 sc0 sc1
    s_mov_b32 s48, 0
P1B_S1_LOOP:
    s_cmp_lg_u32 s48, 1
    s_cbranch_scc1 P1B_S1_NW
    s_waitcnt vmcnt(0)
P1B_S1_NW:
    s_barrier
    s_waitcnt lgkmcnt(7)
    v_mfma_f32_32x32x16_bf16 v[108:123], v[60:63], v[36:39], v[108:123]
    ds_read_b128 v[28:31], v14
    ds_read_b64_tr_b16 v[44:45], v18 offset:0
    ds_read_b64_tr_b16 v[46:47], v18 offset:512
    s_waitcnt lgkmcnt(8)
    v_mfma_f32_32x32x16_bf16 v[124:139], v[64:67], v[36:39], v[124:139]
    ds_read_b64_tr_b16 v[48:49], v18 offset:8192
    ds_read_b64_tr_b16 v[50:51], v18 offset:8704
    s_waitcnt lgkmcnt(7)
    v_mfma_f32_32x32x16_bf16 v[108:123], v[68:71], v[40:43], v[108:123]
    ds_read_b128 v[32:35], v15
    ds_read_b64_tr_b16 v[52:53], v18 offset:2048
    ds_read_b64_tr_b16 v[54:55], v18 offset:2560
    s_waitcnt lgkmcnt(8)
    v_mfma_f32_32x32x16_bf16 v[124:139], v[72:75], v[40:43], v[124:139]
    ds_read_b64_tr_b16 v[56:57], v18 offset:10240
    ds_read_b64_tr_b16 v[58:59], v18 offset:10752
    s_cmp_eq_u32 s48, 1
    s_cbranch_scc1 P1B_F1
P1B_BACK1:
    s_waitcnt lgkmcnt(7)
    v_mfma_f32_32x32x16_bf16 v[108:123], v[44:47], v[28:31], v[108:123]
    ds_read_b128 v[36:39], v16
    ds_read_b64_tr_b16 v[60:61], v18 offset:4096
    ds_read_b64_tr_b16 v[62:63], v18 offset:4608
    s_waitcnt lgkmcnt(8)
    v_mfma_f32_32x32x16_bf16 v[124:139], v[48:51], v[28:31], v[124:139]
    ds_read_b64_tr_b16 v[64:65], v18 offset:12288
    ds_read_b64_tr_b16 v[66:67], v18 offset:12800
    s_waitcnt lgkmcnt(7)
    v_mfma_f32_32x32x16_bf16 v[108:123], v[52:55], v[32:35], v[108:123]
    ds_read_b128 v[40:43], v17
    ds_read_b64_tr_b16 v[68:69], v18 offset:6144
    ds_read_b64_tr_b16 v[70:71], v18 offset:6656
    s_waitcnt lgkmcnt(8)
    v_mfma_f32_32x32x16_bf16 v[124:139], v[56:59], v[32:35], v[124:139]
    ds_read_b64_tr_b16 v[72:73], v18 offset:14336
    ds_read_b64_tr_b16 v[74:75], v18 offset:14848
    s_add_u32 s58, s58, 1
    s_mov_b32 s44, 32768
    s_cmp_eq_u32 s58, 5
    s_cselect_b32 s44, 4294836224, s44
    s_cselect_b32 s58, 0, s58
    v_add_u32 v14, s44, v14
    v_add_u32 v15, s44, v15
    v_add_u32 v16, s44, v16
    v_add_u32 v17, s44, v17
    v_add_u32 v18, s44, v18
    s_add_u32 s48, s48, 1
    s_cmp_lt_u32 s48, 8
    s_cbranch_scc1 P1B_S1_LOOP
    s_waitcnt lgkmcnt(7)
    v_mfma_f32_32x32x16_bf16 v[108:123], v[60:63], v[36:39], v[108:123]
    s_waitcnt lgkmcnt(5)
    v_mfma_f32_32x32x16_bf16 v[124:139], v[64:67], v[36:39], v[124:139]
    s_waitcnt lgkmcnt(2)
    v_mfma_f32_32x32x16_bf16 v[108:123], v[68:71], v[40:43], v[108:123]
    s_waitcnt lgkmcnt(0)
    v_mfma_f32_32x32x16_bf16 v[124:139], v[72:75], v[40:43], v[124:139]
    s_branch P1B_EPI
P1B_F1:
    s_cmp_lg_u32 s40, 0
    s_cbranch_scc1 P1B_F1C
    s_mov_b32 s51, 0x40000
P1B_F1A:
    v_readfirstlane_b32 s50, v150
    v_mov_b32 v2, 0
    s_lshl_b32 s46, s2, 6
    s_add_u32 s46, s46, 19988480
    s_nop 1
    s_cmp_lg_u32 s50, 0
    s_cbranch_scc1 P1B_F1B
    s_cmp_eq_u32 s51, 0
    s_cbranch_scc1 P1B_F1B
    s_sub_u32 s51, s51, 1
    global_load_dwordx2 v[150:151], v2, s[100:101] sc0 sc1
    s_waitcnt vmcnt(0)
    s_branch P1B_F1A
P1B_F1B:
    s_mov_b64 exec, 1
    buffer_store_dwordx2 v[150:151], v2, s[36:39], s46 offen sc0 sc1
    s_mov_b64 exec, -1
P1B_F1C:
    s_branch P1B_BACK1
P1B_G:
    s_waitcnt vmcnt(0)
    v_mov_b32 v23, 0
    v_mov_b32 v24, 0
    v_dot2_f32_bf16 v23, v150, v154, v23
    v_dot2_f32_bf16 v24, v151, v155, v24
    v_dot2_f32_bf16 v23, v152, v156, v23
    v_dot2_f32_bf16 v24, v153, v157, v24
    s_nop 2
    v_add_f32 v23, v23, v24
    s_nop 1
    v_add_f32_dpp v23, v23, v23 quad_perm:[1,0,3,2] row_mask:0xf bank_mask:0xf
    s_nop 1
    v_add_f32_dpp v23, v23, v23 quad_perm:[2,3,0,1] row_mask:0xf bank_mask:0xf
    s_nop 1
    v_add_f32_dpp v23, v23, v23 row_half_mirror row_mask:0xf bank_mask:0xf
    s_nop 1
    v_add_f32_dpp v23, v23, v23 row_mirror row_mask:0xf bank_mask:0xf
    s_nop 0
    v_readlane_b32 s50, v23, 0
    v_readlane_b32 s51, v23, 16
    v_readlane_b32 s52, v23, 32
    v_readlane_b32 s53, v23, 48
    s_mov_b32 s45, s94
    s_nop 0
    v_mov_b32 v23, s50
    v_add_f32 v23, s51, v23
    v_add_f32 v23, s52, v23
    v_add_f32 v23, s53, v23
    v_mul_f32 v23, s84, v23
    v_exp_f32 v23, -v23
    s_lshl_b32 s45, s45, 2
    v_add_f32 v23, 1.0, v23
    v_rcp_f32 v23, v23
    s_add_u32 s45, s45, 19922944
    v_mov_b32 v24, 0
    s_mov_b64 exec, 1
    buffer_store_dword v23, v24, s[36:39], s45 offen sc0 sc1
    s_mov_b64 exec, -1
    s_branch P1B_BACK0
P1B_PF:
    s_cmp_ge_u32 s40, 2
    s_cbranch_scc1 P1B_BACK0
    s_cmp_eq_u32 s40, 0
    s_cselect_b32 s45, s61, s62
    s_bfe_u32 s46, s2, 0x30003
    s_mul_i32 s46, s46, 229376
    s_add_u32 s45, s45, s46
    v_mul_u32_u24 v2, 3584, v1
    buffer_load_dword v27, v2, s[20:23], s45 offen
    s_branch P1B_BACK0
P1B_EPI:
    v_mfma_f32_32x32x16_bf16 v[108:123], v[140:143], v[146:149], v[108:123]
    s_mul_i32 s46, s43, 147456
    s_add_u32 s46, s46, 6324224
    s_lshl_b32 s45, s47, 11
    s_add_u32 s45, s45, s46
    v_mfma_f32_32x32x16_bf16 v[124:139], v[142:145], v[146:149], v[124:139]
    s_lshl_b32 s7, s61, 5
    s_add_u32 s7, s7, s45
    s_add_u32 s76, s7, 0
    s_lshl_b32 s7, s61, 5
    s_add_u32 s7, s7, s45
    s_add_u32 s77, s7, 1024
    s_lshl_b32 s7, s62, 5
    s_add_u32 s7, s7, s45
    s_add_u32 s78, s7, 0
    s_lshl_b32 s7, s62, 5
    s_add_u32 s7, s7, s45
    s_add_u32 s79, s7, 1024
    s_mov_b32 s56, 0
    v_pk_mul_f32 v[76:77], v[108:109], s[84:85]
    v_pk_mul_f32 v[78:79], v[110:111], s[84:85]
    v_pk_mul_f32 v[80:81], v[112:113], s[84:85]
    v_pk_mul_f32 v[82:83], v[114:115], s[84:85]
    v_min_f32 v76, s6, v76
    v_min_f32 v77, s6, v77
    v_min_f32 v78, s6, v78
    v_min_f32 v79, s6, v79
    v_min_f32 v80, s6, v80
    v_min_f32 v81, s6, v81
    v_min_f32 v82, s6, v82
    v_min_f32 v83, s6, v83
    v_exp_f32 v76, v76
    v_exp_f32 v77, v77
    v_exp_f32 v78, v78
    v_exp_f32 v79, v79
    v_exp_f32 v80, v80
    v_exp_f32 v81, v81
    v_exp_f32 v82, v82
    v_exp_f32 v83, v83
    v_pk_add_f32 v[84:85], v[76:77], s[86:87]
    v_pk_add_f32 v[86:87], v[78:79], s[86:87]
    v_pk_add_f32 v[88:89], v[80:81], s[86:87]
    v_pk_add_f32 v[90:91], v[82:83], s[86:87]
    v_pk_mul_f32 v[84:85], v[76:77], v[84:85]
    v_pk_mul_f32 v[86:87], v[78:79], v[86:87]
    v_pk_mul_f32 v[88:89], v[80:81], v[88:89]
    v_pk_mul_f32 v[90:91], v[82:83], v[90:91]
    v_pk_add_f32 v[44:45], v[84:85], s[86:87]
    v_pk_add_f32 v[46:47], v[86:87], s[86:87]
    v_pk_add_f32 v[48:49], v[88:89], s[86:87]
    v_pk_add_f32 v[50:51], v[90:91], s[86:87]
    v_rcp_f32 v44, v44
    v_rcp_f32 v45, v45
    v_rcp_f32 v46, v46
    v_rcp_f32 v47, v47
    v_rcp_f32 v48, v48
    v_rcp_f32 v49, v49
    v_rcp_f32 v50, v50
    v_rcp_f32 v51, v51
    v_pk_mul_f32 v[84:85], v[84:85], v[44:45]
    v_pk_mul_f32 v[86:87], v[86:87], v[46:47]
    v_pk_mul_f32 v[88:89], v[88:89], v[48:49]
    v_pk_mul_f32 v[90:91], v[90:91], v[50:51]
    v_pk_mul_f32 v[76:77], v[108:109], v[84:85]
    v_pk_mul_f32 v[78:79], v[110:111], v[86:87]
    v_pk_mul_f32 v[80:81], v[112:113], v[88:89]
    v_pk_mul_f32 v[82:83], v[114:115], v[90:91]
    v_cvt_pk_bf16_f32 v152, v76, v77
    v_cvt_pk_bf16_f32 v153, v78, v79
    v_cvt_pk_bf16_f32 v154, v80, v81
    v_cvt_pk_bf16_f32 v155, v82, v83
    v_pk_mul_f32 v[76:77], v[116:117], s[84:85]
    v_pk_mul_f32 v[78:79], v[118:119], s[84:85]
    v_pk_mul_f32 v[80:81], v[120:121], s[84:85]
    v_pk_mul_f32 v[82:83], v[122:123], s[84:85]
    v_min_f32 v76, s6, v76
    v_min_f32 v77, s6, v77
    v_min_f32 v78, s6, v78
    v_min_f32 v79, s6, v79
    v_min_f32 v80, s6, v80
    v_min_f32 v81, s6, v81
    v_min_f32 v82, s6, v82
    v_min_f32 v83, s6, v83
    v_exp_f32 v76, v76
    v_exp_f32 v77, v77
    v_exp_f32 v78, v78
    v_exp_f32 v79, v79
    v_exp_f32 v80, v80
    v_exp_f32 v81, v81
    v_exp_f32 v82, v82
    v_exp_f32 v83, v83
    v_pk_add_f32 v[84:85], v[76:77], s[86:87]
    v_pk_add_f32 v[86:87], v[78:79], s[86:87]
    v_pk_add_f32 v[88:89], v[80:81], s[86:87]
    v_pk_add_f32 v[90:91], v[82:83], s[86:87]
    v_pk_mul_f32 v[84:85], v[76:77], v[84:85]
    v_pk_mul_f32 v[86:87], v[78:79], v[86:87]
    v_pk_mul_f32 v[88:89], v[80:81], v[88:89]
    v_pk_mul_f32 v[90:91], v[82:83], v[90:91]
    v_pk_add_f32 v[44:45], v[84:85], s[86:87]
    v_pk_add_f32 v[46:47], v[86:87], s[86:87]
    v_pk_add_f32 v[48:49], v[88:89], s[86:87]
    v_pk_add_f32 v[50:51], v[90:91], s[86:87]
    v_rcp_f32 v44, v44
    v_rcp_f32 v45, v45
    v_rcp_f32 v46, v46
    v_rcp_f32 v47, v47
    v_rcp_f32 v48, v48
    v_rcp_f32 v49, v49
    v_rcp_f32 v50, v50
    v_rcp_f32 v51, v51
    v_pk_mul_f32 v[84:85], v[84:85], v[44:45]
    v_pk_mul_f32 v[86:87], v[86:87], v[46:47]
    v_pk_mul_f32 v[88:89], v[88:89], v[48:49]
    v_pk_mul_f32 v[90:91], v[90:91], v[50:51]
    v_pk_mul_f32 v[76:77], v[116:117], v[84:85]
    v_pk_mul_f32 v[78:79], v[118:119], v[86:87]
    v_pk_mul_f32 v[80:81], v[120:121], v[88:89]
    v_pk_mul_f32 v[82:83], v[122:123], v[90:91]
    v_cvt_pk_bf16_f32 v156, v76, v77
    v_cvt_pk_bf16_f32 v157, v78, v79
    v_cvt_pk_bf16_f32 v158, v80, v81
    v_cvt_pk_bf16_f32 v159, v82, v83
    v_pk_mul_f32 v[76:77], v[124:125], s[84:85]
    v_pk_mul_f32 v[78:79], v[126:127], s[84:85]
    v_pk_mul_f32 v[80:81], v[128:129], s[84:85]
    v_pk_mul_f32 v[82:83], v[130:131], s[84:85]
    v_min_f32 v76, s6, v76
    v_min_f32 v77, s6, v77
    v_min_f32 v78, s6, v78
    v_min_f32 v79, s6, v79
    v_min_f32 v80, s6, v80
    v_min_f32 v81, s6, v81
    v_min_f32 v82, s6, v82
    v_min_f32 v83, s6, v83
    v_exp_f32 v76, v76
    v_exp_f32 v77, v77
    v_exp_f32 v78, v78
    v_exp_f32 v79, v79
    v_exp_f32 v80, v80
    v_exp_f32 v81, v81
    v_exp_f32 v82, v82
    v_exp_f32 v83, v83
    v_pk_add_f32 v[84:85], v[76:77], s[86:87]
    v_pk_add_f32 v[86:87], v[78:79], s[86:87]
    v_pk_add_f32 v[88:89], v[80:81], s[86:87]
    v_pk_add_f32 v[90:91], v[82:83], s[86:87]
    v_pk_mul_f32 v[84:85], v[76:77], v[84:85]
    v_pk_mul_f32 v[86:87], v[78:79], v[86:87]
    v_pk_mul_f32 v[88:89], v[80:81], v[88:89]
    v_pk_mul_f32 v[90:91], v[82:83], v[90:91]
    v_pk_add_f32 v[44:45], v[84:85], s[86:87]
    v_pk_add_f32 v[46:47], v[86:87], s[86:87]
    v_pk_add_f32 v[48:49], v[88:89], s[86:87]
    v_pk_add_f32 v[50:51], v[90:91], s[86:87]
    v_rcp_f32 v44, v44
    v_rcp_f32 v45, v45
    v_rcp_f32 v46, v46
    v_rcp_f32 v47, v47
    v_rcp_f32 v48, v48
    v_rcp_f32 v49, v49
    v_rcp_f32 v50, v50
    v_rcp_f32 v51, v51
    v_pk_mul_f32 v[84:85], v[84:85], v[44:45]
    v_pk_mul_f32 v[86:87], v[86:87], v[46:47]
    v_pk_mul_f32 v[88:89], v[88:89], v[48:49]
    v_pk_mul_f32 v[90:91], v[90:91], v[50:51]
    v_pk_mul_f32 v[76:77], v[124:125], v[84:85]
    v_pk_mul_f32 v[78:79], v[126:127], v[86:87]
    v_pk_mul_f32 v[80:81], v[128:129], v[88:89]
    v_pk_mul_f32 v[82:83], v[130:131], v[90:91]
    v_cvt_pk_bf16_f32 v160, v76, v77
    v_cvt_pk_bf16_f32 v161, v78, v79
    v_cvt_pk_bf16_f32 v162, v80, v81
    v_cvt_pk_bf16_f32 v163, v82, v83
    v_pk_mul_f32 v[76:77], v[132:133], s[84:85]
    v_pk_mul_f32 v[78:79], v[134:135], s[84:85]
    v_pk_mul_f32 v[80:81], v[136:137], s[84:85]
    v_pk_mul_f32 v[82:83], v[138:139], s[84:85]
    v_min_f32 v76, s6, v76
    v_min_f32 v77, s6, v77
    v_min_f32 v78, s6, v78
    v_min_f32 v79, s6, v79
    v_min_f32 v80, s6, v80
    v_min_f32 v81, s6, v81
    v_min_f32 v82, s6, v82
    v_min_f32 v83, s6, v83
    v_exp_f32 v76, v76
    v_exp_f32 v77, v77
    v_exp_f32 v78, v78
    v_exp_f32 v79, v79
    v_exp_f32 v80, v80
    v_exp_f32 v81, v81
    v_exp_f32 v82, v82
    v_exp_f32 v83, v83
    v_pk_add_f32 v[84:85], v[76:77], s[86:87]
    v_pk_add_f32 v[86:87], v[78:79], s[86:87]
    v_pk_add_f32 v[88:89], v[80:81], s[86:87]
    v_pk_add_f32 v[90:91], v[82:83], s[86:87]
    v_pk_mul_f32 v[84:85], v[76:77], v[84:85]
    v_pk_mul_f32 v[86:87], v[78:79], v[86:87]
    v_pk_mul_f32 v[88:89], v[80:81], v[88:89]
    v_pk_mul_f32 v[90:91], v[82:83], v[90:91]
    v_pk_add_f32 v[44:45], v[84:85], s[86:87]
    v_pk_add_f32 v[46:47], v[86:87], s[86:87]
    v_pk_add_f32 v[48:49], v[88:89], s[86:87]
    v_pk_add_f32 v[50:51], v[90:91], s[86:87]
    v_rcp_f32 v44, v44
    v_rcp_f32 v45, v45
    v_rcp_f32 v46, v46
    v_rcp_f32 v47, v47
    v_rcp_f32 v48, v48
    v_rcp_f32 v49, v49
    v_rcp_f32 v50, v50
    v_rcp_f32 v51, v51
    v_pk_mul_f32 v[84:85], v[84:85], v[44:45]
    v_pk_mul_f32 v[86:87], v[86:87], v[46:47]
    v_pk_mul_f32 v[88:89], v[88:89], v[48:49]
    v_pk_mul_f32 v[90:91], v[90:91], v[50:51]
    v_pk_mul_f32 v[76:77], v[132:133], v[84:85]
    v_pk_mul_f32 v[78:79], v[134:135], v[86:87]
    v_pk_mul_f32 v[80:81], v[136:137], v[88:89]
    v_pk_mul_f32 v[82:83], v[138:139], v[90:91]
    v_cvt_pk_bf16_f32 v164, v76, v77
    v_cvt_pk_bf16_f32 v165, v78, v79
    v_cvt_pk_bf16_f32 v166, v80, v81
    v_cvt_pk_bf16_f32 v167, v82, v83
    s_branch P2_ATT
P2_ATT:
    s_mov_b32 s54, 0xffff
    s_mov_b32 s55, 0xffff
    v_and_b32 v2, 27, v1
    v_cmp_eq_u32 vcc, 16, v2
    v_mov_b32 v2, 0x3f803f80
    s_lshl_b32 s44, s40, 10
    v_cndmask_b32 v96, 0, v2, vcc
    v_mov_b32 v97, v96
    v_mov_b32 v98, v96
    v_mov_b32 v99, v96
    v_mov_b32 v100, v96
    v_mov_b32 v101, v96
    v_mov_b32 v102, v96
    v_mov_b32 v103, v96
    v_mov_b32 v104, v96
    v_mov_b32 v105, v96
    v_mov_b32 v106, v96
    v_mov_b32 v107, v96
    v_mov_b32 v108, v96
    v_mov_b32 v109, v96
    v_mov_b32 v110, v96
    v_mov_b32 v111, v96
    s_add_u32 s44, s44, 147456
    v_add_u32 v2, s44, v11
    v_and_b32 v8, 31, v1
    v_lshlrev_b32 v8, 2, v8
    s_lshl_b32 s44, s40, 7
    s_add_u32 s44, s44, 155648
    v_add_u32 v8, s44, v8
    v_mov_b32 v148, -1
    v_mov_b32 v149, -1
    v_mov_b32 v150, -1
    v_mov_b32 v151, -1
    s_mov_b32 s51, 1
    s_mov_b32 s53, 8
    s_mov_b32 s52, 6
    s_setprio 2
    s_barrier
    ds_read_b128 v[12:15], v2
    ds_read_b32 v6, v8
P2_MAXPASS:
    v_mov_b32 v4, v11
    v_mov_b32 v7, 0xff800000
    s_mov_b32 s50, s51
P2_MAXLOOP:
    ds_read_b128 v[88:91], v4
    v_add_u32 v4, 2048, v4
    s_waitcnt lgkmcnt(0)
    v_mfma_f32_32x32x16_bf16 v[32:47], v[88:91], v[12:15], 0
    s_nop 11
    v_max3_f32 v7, v32, v33, v7
    v_max3_f32 v7, v34, v35, v7
    v_max3_f32 v7, v36, v37, v7
    v_max3_f32 v7, v38, v39, v7
    v_max3_f32 v7, v40, v41, v7
    v_max3_f32 v7, v42, v43, v7
    v_max3_f32 v7, v44, v45, v7
    v_max3_f32 v7, v46, v47, v7
    s_sub_u32 s50, s50, 1
    s_cmp_lg_u32 s50, 0
    s_cbranch_scc1 P2_MAXLOOP
    v_mov_b32 v2, v7
    v_mov_b32 v4, v11
    v_and_b32 v8, 15, v1
    v_permlane32_swap_b32 v7, v2
    v_lshlrev_b32 v5, 4, v8
    v_lshrrev_b32 v8, 5, v1
    v_max_f32 v7, v7, v2
    v_lshl_add_u32 v5, v8, 8, v5
    v_add_u32 v5, 1024, v5
    ds_read_b128 v[88:91], v4 offset:0
    ds_read_b128 v[92:95], v4 offset:2048
    s_mov_b64 exec, s[54:55]
    ds_read_b128 v[96:99], v5 offset:0
    ds_read_b128 v[100:103], v5 offset:512
    s_mov_b64 exec, -1
    v_sub_f32 v16, 0, v7
    v_sub_f32 v17, 0, v7
    v_sub_f32 v18, 0, v7
    v_sub_f32 v19, 0, v7
    v_sub_f32 v20, 0, v7
    v_sub_f32 v21, 0, v7
    v_sub_f32 v22, 0, v7
    v_sub_f32 v23, 0, v7
    v_sub_f32 v24, 0, v7
    v_sub_f32 v25, 0, v7
    v_sub_f32 v26, 0, v7
    v_sub_f32 v27, 0, v7
    v_sub_f32 v28, 0, v7
    v_sub_f32 v29, 0, v7
    v_sub_f32 v30, 0, v7
    v_sub_f32 v31, 0, v7
    v_mov_b32 v56, 0
    v_mov_b32 v57, 0
    v_mov_b32 v58, 0
    v_mov_b32 v59, 0
    v_mov_b32 v60, 0
    v_mov_b32 v61, 0
    v_mov_b32 v62, 0
    v_mov_b32 v63, 0
    v_mov_b32 v9, 0xdddddddd
    s_waitcnt lgkmcnt(3)
    v_mfma_f32_32x32x16_bf16 v[32:47], v[88:91], v[12:15], v[16:31]
    v_mov_b32 v64, 0
    v_mov_b32 v65, 0
    v_mov_b32 v66, 0
    v_mov_b32 v67, 0
    v_mov_b32 v68, 0
    v_mov_b32 v69, 0
    v_mov_b32 v70, 0
    v_mov_b32 v71, 0
    v_mov_b32 v72, 0
    v_mov_b32 v73, 0
    v_mov_b32 v74, 0
    v_mov_b32 v75, 0
    v_mov_b32 v76, 0
    v_mov_b32 v77, 0
    v_mov_b32 v78, 0
    v_mov_b32 v79, 0
    s_mov_b32 s50, 8
P2_LOOP:
    v_exp_f32 v32, v32
    v_exp_f32 v33, v33
    v_smfmac_f32_32x32x32_bf16 v[64:79], v[108:111], v[56:63], v9
    s_mov_b64 exec, s[54:55]
    ds_read_b128 v[104:107], v5 offset:2048
    ds_read_b128 v[108:111], v5 offset:2560
    s_mov_b64 exec, -1
    v_exp_f32 v34, v34
    v_exp_f32 v35, v35
    v_exp_f32 v36, v36
    s_waitcnt lgkmcnt(2)
    v_mfma_f32_32x32x16_bf16 v[48:63], v[92:95], v[12:15], v[16:31]
    ds_read_b128 v[88:91], v4 offset:4096
    v_exp_f32 v37, v37
    v_exp_f32 v38, v38
    v_exp_f32 v39, v39
    v_exp_f32 v40, v40
    v_exp_f32 v41, v41
    v_exp_f32 v42, v42
    v_smfmac_f32_32x32x32_bf16 v[64:79], v[96:99], v[32:39], v9
    v_exp_f32 v43, v43
    v_exp_f32 v44, v44
    v_exp_f32 v45, v45
    v_exp_f32 v46, v46
    v_exp_f32 v47, v47
    v_exp_f32 v48, v48
    v_exp_f32 v49, v49
    v_smfmac_f32_32x32x32_bf16 v[64:79], v[100:103], v[40:47], v9
    s_mov_b64 exec, s[54:55]
    ds_read_b128 v[96:99], v5 offset:4096
    ds_read_b128 v[100:103], v5 offset:4608
    s_mov_b64 exec, -1
    v_exp_f32 v50, v50
    v_exp_f32 v51, v51
    v_exp_f32 v52, v52
    s_waitcnt lgkmcnt(2)
    v_mfma_f32_32x32x16_bf16 v[32:47], v[88:91], v[12:15], v[16:31]
    ds_read_b128 v[92:95], v4 offset:6144
    v_exp_f32 v53, v53
    v_exp_f32 v54, v54
    v_exp_f32 v55, v55
    v_exp_f32 v56, v56
    v_exp_f32 v57, v57
    v_exp_f32 v58, v58
    v_smfmac_f32_32x32x32_bf16 v[64:79], v[104:107], v[48:55], v9
    v_exp_f32 v59, v59
    v_exp_f32 v60, v60
    v_exp_f32 v61, v61
    v_exp_f32 v62, v62
    v_exp_f32 v63, v63
    v_exp_f32 v32, v32
    v_exp_f32 v33, v33
    v_smfmac_f32_32x32x32_bf16 v[64:79], v[108:111], v[56:63], v9
    s_mov_b64 exec, s[54:55]
    ds_read_b128 v[104:107], v5 offset:6144
    ds_read_b128 v[108:111], v5 offset:6656
    s_mov_b64 exec, -1
    v_exp_f32 v34, v34
    v_exp_f32 v35, v35
    v_exp_f32 v36, v36
    s_waitcnt lgkmcnt(2)
    v_mfma_f32_32x32x16_bf16 v[48:63], v[92:95], v[12:15], v[16:31]
    ds_read_b128 v[88:91], v4 offset:8192
    v_exp_f32 v37, v37
    v_exp_f32 v38, v38
    v_exp_f32 v39, v39
    v_exp_f32 v40, v40
    v_exp_f32 v41, v41
    v_exp_f32 v42, v42
    v_smfmac_f32_32x32x32_bf16 v[64:79], v[96:99], v[32:39], v9
    v_exp_f32 v43, v43
    v_exp_f32 v44, v44
    v_exp_f32 v45, v45
    v_exp_f32 v46, v46
    v_exp_f32 v47, v47
    v_exp_f32 v48, v48
    v_exp_f32 v49, v49
    v_smfmac_f32_32x32x32_bf16 v[64:79], v[100:103], v[40:47], v9
    s_mov_b64 exec, s[54:55]
    ds_read_b128 v[96:99], v5 offset:8192
    ds_read_b128 v[100:103], v5 offset:8704
    s_mov_b64 exec, -1
    v_exp_f32 v50, v50
    v_exp_f32 v51, v51
    v_exp_f32 v52, v52
    s_waitcnt lgkmcnt(2)
    v_mfma_f32_32x32x16_bf16 v[32:47], v[88:91], v[12:15], v[16:31]
    ds_read_b128 v[92:95], v4 offset:10240
    v_exp_f32 v53, v53
    v_exp_f32 v54, v54
    v_exp_f32 v55, v55
    v_exp_f32 v56, v56
    v_exp_f32 v57, v57
    v_exp_f32 v58, v58
    v_smfmac_f32_32x32x32_bf16 v[64:79], v[104:107], v[48:55], v9
    v_exp_f32 v59, v59
    v_exp_f32 v60, v60
    v_exp_f32 v61, v61
    v_exp_f32 v62, v62
    v_exp_f32 v63, v63
    v_exp_f32 v32, v32
    v_exp_f32 v33, v33
    v_smfmac_f32_32x32x32_bf16 v[64:79], v[108:111], v[56:63], v9
    s_mov_b64 exec, s[54:55]
    ds_read_b128 v[104:107], v5 offset:10240
    ds_read_b128 v[108:111], v5 offset:10752
    s_mov_b64 exec, -1
    v_exp_f32 v34, v34
    v_exp_f32 v35, v35
    v_exp_f32 v36, v36
    s_waitcnt lgkmcnt(2)
    v_mfma_f32_32x32x16_bf16 v[48:63], v[92:95], v[12:15], v[16:31]
    ds_read_b128 v[88:91], v4 offset:12288
    v_exp_f32 v37, v37
    v_exp_f32 v38, v38
    v_exp_f32 v39, v39
    v_exp_f32 v40, v40
    v_exp_f32 v41, v41
    v_exp_f32 v42, v42
    v_smfmac_f32_32x32x32_bf16 v[64:79], v[96:99], v[32:39], v9
    v_exp_f32 v43, v43
    v_exp_f32 v44, v44
    v_exp_f32 v45, v45
    v_exp_f32 v46, v46
    v_exp_f32 v47, v47
    v_exp_f32 v48, v48
    v_exp_f32 v49, v49
    v_smfmac_f32_32x32x32_bf16 v[64:79], v[100:103], v[40:47], v9
    s_mov_b64 exec, s[54:55]
    ds_read_b128 v[96:99], v5 offset:12288
    ds_read_b128 v[100:103], v5 offset:12800
    s_mov_b64 exec, -1
    v_exp_f32 v50, v50
    v_exp_f32 v51, v51
    v_exp_f32 v52, v52
    s_waitcnt lgkmcnt(2)
    v_mfma_f32_32x32x16_bf16 v[32:47], v[88:91], v[12:15], v[16:31]
    ds_read_b128 v[92:95], v4 offset:14336
    v_exp_f32 v53, v53
    v_exp_f32 v54, v54
    v_exp_f32 v55, v55
    v_exp_f32 v56, v56
    v_exp_f32 v57, v57
    v_exp_f32 v58, v58
    v_smfmac_f32_32x32x32_bf16 v[64:79], v[104:107], v[48:55], v9
    v_exp_f32 v59, v59
    v_exp_f32 v60, v60
    v_exp_f32 v61, v61
    v_exp_f32 v62, v62
    v_exp_f32 v63, v63
    v_exp_f32 v32, v32
    v_exp_f32 v33, v33
    v_smfmac_f32_32x32x32_bf16 v[64:79], v[108:111], v[56:63], v9
    s_mov_b64 exec, s[54:55]
    ds_read_b128 v[104:107], v5 offset:14336
    ds_read_b128 v[108:111], v5 offset:14848
    s_mov_b64 exec, -1
    v_exp_f32 v34, v34
    v_exp_f32 v35, v35
    v_exp_f32 v36, v36
    s_waitcnt lgkmcnt(2)
    v_mfma_f32_32x32x16_bf16 v[48:63], v[92:95], v[12:15], v[16:31]
    ds_read_b128 v[88:91], v4 offset:16384
    v_exp_f32 v37, v37
    v_exp_f32 v38, v38
    v_exp_f32 v39, v39
    v_exp_f32 v40, v40
    v_exp_f32 v41, v41
    v_exp_f32 v42, v42
    v_smfmac_f32_32x32x32_bf16 v[64:79], v[96:99], v[32:39], v9
    v_exp_f32 v43, v43
    v_exp_f32 v44, v44
    v_exp_f32 v45, v45
    v_exp_f32 v46, v46
    v_exp_f32 v47, v47
    v_exp_f32 v48, v48
    v_exp_f32 v49, v49
    v_smfmac_f32_32x32x32_bf16 v[64:79], v[100:103], v[40:47], v9
    s_mov_b64 exec, s[54:55]
    ds_read_b128 v[96:99], v5 offset:16384
    ds_read_b128 v[100:103], v5 offset:16896
    s_mov_b64 exec, -1
    v_exp_f32 v50, v50
    v_exp_f32 v51, v51
    v_exp_f32 v52, v52
    s_waitcnt lgkmcnt(2)
    v_mfma_f32_32x32x16_bf16 v[32:47], v[88:91], v[12:15], v[16:31]
    ds_read_b128 v[92:95], v4 offset:18432
    v_exp_f32 v53, v53
    v_exp_f32 v54, v54
    v_exp_f32 v55, v55
    v_exp_f32 v56, v56
    v_exp_f32 v57, v57
    v_exp_f32 v58, v58
    v_smfmac_f32_32x32x32_bf16 v[64:79], v[104:107], v[48:55], v9
    v_exp_f32 v59, v59
    v_exp_f32 v60, v60
    v_exp_f32 v61, v61
    v_exp_f32 v62, v62
    v_exp_f32 v63, v63
    v_add_u32 v4, 0x4000, v4
    v_add_u32 v5, 0x4000, v5
    s_cmp_lg_u32 s53, s50
    s_cbranch_scc1 P2_NOBAR0
    s_mov_b32 s53, 100
    buffer_store_dwordx4 v[152:155], v11, s[36:39], s76 offen sc0 sc1
    buffer_store_dwordx4 v[156:159], v11, s[36:39], s77 offen sc0 sc1
    s_cmp_eq_u32 s56, 1
    s_cbranch_scc1 P2_NOH3
    buffer_store_dwordx4 v[160:163], v11, s[36:39], s78 offen sc0 sc1
    buffer_store_dwordx4 v[164:167], v11, s[36:39], s79 offen sc0 sc1
P2_NOH3:
    buffer_store_dwordx4 v[148:151], v11, s[36:39], s97 offen sc0 sc1
    s_barrier
P2_NOBAR0:
    s_cmp_lg_u32 s52, s50
    s_cbranch_scc1 P2_NOBAR
    s_mov_b32 s52, 100
    s_waitcnt vmcnt(0)
    s_barrier
P2_NOBAR:
    s_cmp_lg_u32 s50, 5
    s_cbranch_scc1 P2_NP1
    s_setprio 1
P2_NP1:
    s_cmp_lg_u32 s50, 2
    s_cbranch_scc1 P2_NP2
    s_setprio 0
P2_NP2:
    s_sub_u32 s50, s50, 1
    s_cmp_lg_u32 s50, 0
    s_cbranch_scc1 P2_LOOP
    v_smfmac_f32_32x32x32_bf16 v[64:79], v[108:111], v[56:63], v9
    s_waitcnt lgkmcnt(0)
    s_nop 11
    v_mov_b32 v2, v72
    v_rcp_f32 v8, v72
    v_fma_f32 v2, v64, 0, v2
    v_fma_f32 v2, v65, 0, v2
    v_fma_f32 v2, v66, 0, v2
    v_fma_f32 v2, v67, 0, v2
    v_fma_f32 v2, v68, 0, v2
    v_fma_f32 v2, v69, 0, v2
    v_fma_f32 v2, v70, 0, v2
    v_fma_f32 v2, v71, 0, v2
    v_cmp_gt_f32 vcc, 0x71800000, v2
    v_mul_f32 v8, v8, v6
    s_nop 3
    s_cmp_eq_u64 vcc, -1
    s_cbranch_scc1 P2_OK
    s_cmp_eq_u32 s51, 64
    s_cbranch_scc1 P2_OK
    s_mov_b32 s51, 64
    s_branch P2_MAXPASS
P2_OK:
    v_mul_f32 v64, v64, v8
    v_mul_f32 v65, v65, v8
    v_mul_f32 v66, v66, v8
    v_mul_f32 v67, v67, v8
    v_mul_f32 v68, v68, v8
    v_mul_f32 v69, v69, v8
    v_mul_f32 v70, v70, v8
    v_mul_f32 v71, v71, v8
    v_cvt_pk_bf16_f32 v80, v64, v65
    v_cvt_pk_bf16_f32 v81, v66, v67
    v_cvt_pk_bf16_f32 v82, v68, v69
    v_cvt_pk_bf16_f32 v83, v70, v71
    buffer_store_dwordx4 v[80:83], v11, s[36:39], s97 offen sc0 sc1
    s_endpgm
P2_SHADOW:
    s_load_dwordx2 s[12:13], s[0:1], 64
    s_setprio 3
    v_mov_b32 v3, v11
    v_mov_b32 v2, 0
    s_mov_b32 s87, 0x40000
    s_and_b32 s44, s2, 6
    s_and_b32 s45, s2, 1
    s_lshl_b32 s45, s45, 6
    s_or_b32 s44, s44, s45
    v_and_b32 v6, 1, v1
    v_bfe_u32 v7, v1, 1, 3
    v_lshl_or_b32 v6, v7, 3, v6
    v_bfe_u32 v7, v1, 4, 1
    v_lshl_or_b32 v6, v7, 7, v6
    v_or_b32 v6, s44, v6
    v_xor_b32 v7, 1, v7
    v_lshlrev_b32 v7, 2, v7
    v_xor_b32 v6, v7, v6
    s_lshr_b32 s44, s96, 2
    s_and_b32 s45, s96, 3
    s_lshl_b32 s45, s45, 4
    s_or_b32 s44, s44, s45
    v_and_b32 v7, 6, v1
    v_or_b32 v7, s44, v7
    v_bfe_u32 v12, v1, 4, 1
    v_lshl_or_b32 v7, v12, 3, v7
    v_and_b32 v12, 1, v1
    v_lshl_or_b32 v7, v12, 6, v7
    v_bfe_u32 v12, v1, 3, 1
    v_lshl_or_b32 v7, v12, 7, v7
    v_cmp_gt_u32 vcc, 32, v1
    s_lshl_b32 s20, s95, 17
    s_lshl_b32 s21, s63, 10
    v_cndmask_b32 v6, v7, v6, vcc
    v_lshlrev_b32 v6, 6, v6
    s_add_u32 s20, s20, s21
    s_add_u32 s20, s20, 2097152
    s_lshl_b32 s46, s2, 6
    s_add_u32 s46, s46, 19988480
    s_mov_b32 s84, 19988480
    global_load_dwordx2 v[4:5], v2, s[100:101] sc0 sc1
    buffer_load_dwordx2 v[8:9], v6, s[36:39], s84 offen sc0 sc1
    s_waitcnt vmcnt(2) lgkmcnt(0)
    s_barrier
    s_waitcnt vmcnt(0)
    s_mov_b32 s14, 2097152
    s_mov_b32 s15, 0x00020000
P2_F1CHK:
    v_readfirstlane_b32 s8, v4
    v_readfirstlane_b32 s9, v5
    s_nop 1
    v_cmp_eq_u64 vcc, s[8:9], v[8:9]
    s_cmp_eq_u32 s8, 0
    s_cbranch_scc1 P2_F1RE
    s_nop 3
    s_cmp_eq_u64 vcc, -1
    s_cbranch_scc1 P2_F1GOT
P2_F1RE:
    s_cmp_eq_u32 s87, 0
    s_cbranch_scc1 P2_F1GOT
    s_sub_u32 s87, s87, 1
    s_sleep 8
    global_load_dwordx2 v[4:5], v2, s[100:101] sc0 sc1
    buffer_load_dwordx2 v[8:9], v6, s[36:39], s84 offen sc0 sc1
    s_waitcnt vmcnt(0)
    s_branch P2_F1CHK
P2_F1GOT:
    s_lshl_b32 s44, s95, 6
    s_lshl_b32 s45, s96, 3
    s_add_u32 s44, s44, s45
    s_lshl_b32 s45, s63, 1
    s_add_u32 s44, s44, s45
    s_lshl_b32 s44, s44, 10
    s_lshl_b32 s45, s63, 11
    s_add_u32 m0, s45, 147456
    s_lshl_b32 s45, s96, 10
    buffer_load_dwordx4 v3, s[36:39], s44 offen lds
    buffer_load_dwordx4 v3, s[36:39], s44 offen offset:1024 lds
    s_mov_b32 m0, 155648
    s_add_u32 s45, s45, 19922944
    buffer_load_dwordx4 v3, s[36:39], s45 offen lds
    s_mov_b32 s50, 5
P2_KVLOOP0:
    s_mov_b32 m0, s21
    s_add_u32 s21, s21, 4096
    buffer_load_dwordx4 v3, s[36:39], s20 offen lds
    s_add_u32 s20, s20, 4096
    s_sub_u32 s50, s50, 1
    s_cmp_lg_u32 s50, 0
    s_cbranch_scc1 P2_KVLOOP0
    s_waitcnt vmcnt(0)
    s_barrier
    s_mov_b32 s50, 11
P2_KVLOOP1:
    s_mov_b32 m0, s21
    s_add_u32 s21, s21, 4096
    buffer_load_dwordx4 v3, s[36:39], s20 offen lds
    s_add_u32 s20, s20, 4096
    s_sub_u32 s50, s50, 1
    s_cmp_lg_u32 s50, 0
    s_cbranch_scc1 P2_KVLOOP1
    s_waitcnt vmcnt(0)
    s_barrier
    s_mov_b32 s18, 524288
    s_mov_b32 s19, 0x00020000
    s_mov_b32 s30, 1835008
    s_mov_b32 s31, 0x00020000
    s_lshl_b32 s84, s63, 12
    s_add_u32 s84, s84, 131072
    v_lshrrev_b32 v12, 5, v1
    v_bfe_u32 v13, v1, 2, 2
    v_and_b32 v14, 3, v1
    v_bfe_u32 v15, v1, 4, 1
    v_lshlrev_b32 v10, 9, v12
    v_lshl_add_u32 v10, v13, 7, v10
    v_lshrrev_b32 v16, 1, v13
    v_lshl_add_u32 v10, v16, 6, v10
    v_lshl_add_u32 v10, v15, 4, v10
    v_and_b32 v16, 1, v14
    v_lshl_add_u32 v10, v16, 5, v10
    v_lshrrev_b32 v16, 1, v14
    v_lshl_add_u32 v10, v16, 3, v10
    v_add_u32 v10, s84, v10
    v_xor_b32 v11, 64, v10
    s_lshl_b32 s52, s2, 2
    s_add_u32 s52, s52, s63
    s_mul_i32 s53, s52, 7282
    s_lshr_b32 s53, s53, 20
    s_mul_i32 s54, s53, 144
    s_sub_u32 s54, s52, s54
    s_add_u32 s56, s52, s52
    s_sub_u32 s56, s56, s54
    s_lshl_b32 s56, s56, 10
    s_lshl_b32 s44, s54, 14
    s_lshl_b32 s45, s53, 7
    s_add_u32 s44, s44, s45
    s_add_u32 m0, s84, 0
    s_cmp_ge_u32 s54, 32
    s_cbranch_scc1 P2_TW20
    s_add_u32 s45, s44, 7168
    buffer_load_dwordx4 v22, s[16:19], s44 offen lds
    buffer_load_dwordx4 v22, s[16:19], s45 offen offset:1024 lds
    s_branch P2_TD0
P2_TW20:
    s_sub_u32 s44, s44, 524288
    s_add_u32 s45, s44, 7168
    buffer_load_dwordx4 v22, s[28:31], s44 offen lds
    buffer_load_dwordx4 v22, s[28:31], s45 offen offset:1024 lds
P2_TD0:
    s_cmp_ge_u32 s52, 128
    s_cbranch_scc1 P2_TR1
    s_add_u32 s52, s52, 1024
    s_mul_i32 s53, s52, 7282
    s_lshr_b32 s53, s53, 20
    s_mul_i32 s54, s53, 144
    s_sub_u32 s54, s52, s54
    s_add_u32 s57, s52, s52
    s_sub_u32 s57, s57, s54
    s_lshl_b32 s57, s57, 10
    s_lshl_b32 s44, s54, 14
    s_lshl_b32 s45, s53, 7
    s_add_u32 s44, s44, s45
    s_add_u32 m0, s84, 2048
    s_cmp_ge_u32 s54, 32
    s_cbranch_scc1 P2_TW21
    s_add_u32 s45, s44, 7168
    buffer_load_dwordx4 v22, s[16:19], s44 offen lds
    buffer_load_dwordx4 v22, s[16:19], s45 offen offset:1024 lds
    s_branch P2_TD1
P2_TW21:
    s_sub_u32 s44, s44, 524288
    s_add_u32 s45, s44, 7168
    buffer_load_dwordx4 v22, s[28:31], s44 offen lds
    buffer_load_dwordx4 v22, s[28:31], s45 offen offset:1024 lds
P2_TD1:
P2_TR1:
    s_mov_b32 s50, 16
P2_KVLOOP2:
    s_mov_b32 m0, s21
    s_add_u32 s21, s21, 4096
    buffer_load_dwordx4 v3, s[36:39], s20 offen lds
    s_add_u32 s20, s20, 4096
    s_sub_u32 s50, s50, 1
    s_cmp_lg_u32 s50, 0
    s_cbranch_scc1 P2_KVLOOP2
    s_waitcnt vmcnt(16)
    ds_read_b64_tr_b16 v[24:25], v10 offset:0
    ds_read_b64_tr_b16 v[26:27], v10 offset:1024
    ds_read_b64_tr_b16 v[28:29], v11 offset:0
    ds_read_b64_tr_b16 v[30:31], v11 offset:1024
    ds_read_b64_tr_b16 v[32:33], v10 offset:2048
    ds_read_b64_tr_b16 v[34:35], v10 offset:3072
    ds_read_b64_tr_b16 v[36:37], v11 offset:2048
    ds_read_b64_tr_b16 v[38:39], v11 offset:3072
    s_waitcnt lgkmcnt(0)
    s_add_u32 s7, s56, 16777216
    buffer_store_dwordx4 v[24:27], v3, s[36:39], s7 offen sc0 sc1
    s_add_u32 s7, s56, 16924672
    buffer_store_dwordx4 v[28:31], v3, s[36:39], s7 offen sc0 sc1
    s_cmp_lt_u32 s52, 1024
    s_cbranch_scc1 P2_TR2
    s_add_u32 s7, s57, 16777216
    buffer_store_dwordx4 v[32:35], v3, s[36:39], s7 offen sc0 sc1
    s_add_u32 s7, s57, 16924672
    buffer_store_dwordx4 v[36:39], v3, s[36:39], s7 offen sc0 sc1
P2_TR2:
    s_lshr_b32 s44, s63, 1
    s_lshl_b32 s45, s96, 1
    s_add_u32 s80, s45, s44
    s_xor_b32 s81, s80, 1
    s_and_b32 s44, s63, 1
    s_lshl_b32 s45, s95, 1
    s_add_u32 s82, s45, s44
    s_xor_b32 s83, s82, 1
    s_mov_b32 s22, s80
    s_mov_b32 s23, s82
    s_lshl_b32 s32, s82, 7
    s_add_u32 s32, s32, 19922944
    s_lshl_b32 s33, s83, 7
    s_add_u32 s33, s33, 19922944
    s_lshl_b32 s44, s63, 13
    s_mul_i32 s24, s80, 147456
    s_add_u32 s24, s24, s44
    s_add_u32 s24, s24, 16777216
    s_mul_i32 s25, s81, 147456
    s_add_u32 s25, s25, s44
    s_add_u32 s25, s25, 16777216
    s_lshl_b32 s26, s82, 15
    s_add_u32 s26, s26, s44
    s_add_u32 s26, s26, 20971520
    s_lshl_b32 s27, s83, 15
    s_add_u32 s27, s27, s44
    s_add_u32 s27, s27, 20971520
    s_mul_i32 s44, s63, 28672
    s_mul_i32 s80, s80, 147456
    s_add_u32 s80, s80, s44
    s_add_u32 s80, s80, 16809984
    s_mul_i32 s81, s81, 147456
    s_add_u32 s81, s81, s44
    s_add_u32 s81, s81, 16809984
    s_mul_i32 s82, s82, 147456
    s_add_u32 s82, s82, s44
    s_add_u32 s82, s82, 6324224
    s_mul_i32 s83, s83, 147456
    s_add_u32 s83, s83, s44
    s_add_u32 s83, s83, 6324224
    s_lshr_b32 s44, s95, 1
    s_lshr_b32 s45, s44, 3
    s_and_b32 s44, s44, 7
    s_lshl_b32 s44, s44, 3
    s_or_b32 s44, s44, s45
    v_and_b32 v6, 6, v1
    v_and_b32 v7, 1, v1
    v_lshl_or_b32 v6, v7, 6, v6
    v_bfe_u32 v7, v1, 3, 1
    v_lshl_or_b32 v6, v7, 7, v6
    v_or_b32 v6, s44, v6
    s_mul_i32 s44, s96, 36
    v_subrev_u32 v7, 16, v1
    v_min_u32 v7, 35, v7
    v_add_u32 v7, s44, v7
    v_and_b32 v7, 255, v7
    v_cmp_gt_u32 vcc, 16, v1
    s_add_u32 s46, s46, 16384
    s_mov_b32 s84, 20004864
    v_cndmask_b32 v6, v7, v6, vcc
    v_lshlrev_b32 v6, 6, v6
    s_lshr_b32 s44, s95, 2
    s_lshl_b32 s44, s44, 5
    v_and_b32 v7, 31, v1
    v_add_u32 v7, s44, v7
    v_lshlrev_b32 v7, 6, v7
    s_waitcnt vmcnt(0)
    s_barrier
    s_cmp_lg_u32 s63, 0
    s_cbranch_scc1 P2_F2POLL
    s_mov_b64 exec, 1
    buffer_store_dwordx2 v[4:5], v2, s[36:39], s46 offen sc0 sc1
    s_mov_b64 exec, -1
P2_F2POLL:
    s_mov_b32 s20, 20004864
P2_F2P:
    buffer_load_dwordx2 v[160:161], v6, s[36:39], s20 offen sc0 sc1
    s_waitcnt vmcnt(0)
    v_cmp_eq_u64 vcc, s[8:9], v[160:161]
    s_nop 4
    s_cmp_eq_u64 vcc, -1
    s_cbranch_scc1 P2_F2GOT
    s_cmp_eq_u32 s87, 0
    s_cbranch_scc1 P2_F2GOT
    s_sub_u32 s87, s87, 1
    s_sleep 8
    s_branch P2_F2P
P2_F2GOT:
    buffer_load_dwordx4 v[72:75], v3, s[36:39], s80 offen offset:0
    buffer_load_dwordx4 v[76:79], v3, s[36:39], s82 offen offset:0
    buffer_load_dwordx4 v[80:83], v3, s[36:39], s81 offen offset:0
    buffer_load_dwordx4 v[84:87], v3, s[36:39], s83 offen offset:0
    buffer_load_dwordx4 v[88:91], v3, s[36:39], s80 offen offset:1024
    buffer_load_dwordx4 v[92:95], v3, s[36:39], s82 offen offset:1024
    buffer_load_dwordx4 v[96:99], v3, s[36:39], s81 offen offset:1024
    buffer_load_dwordx4 v[100:103], v3, s[36:39], s83 offen offset:1024
    buffer_load_dwordx4 v[104:107], v3, s[36:39], s80 offen offset:2048
    buffer_load_dwordx4 v[108:111], v3, s[36:39], s82 offen offset:2048
    buffer_load_dwordx4 v[112:115], v3, s[36:39], s81 offen offset:2048
    buffer_load_dwordx4 v[116:119], v3, s[36:39], s83 offen offset:2048
    buffer_load_dwordx4 v[120:123], v3, s[36:39], s80 offen offset:3072
    buffer_load_dwordx4 v[124:127], v3, s[36:39], s82 offen offset:3072
    buffer_load_dwordx4 v[128:131], v3, s[36:39], s81 offen offset:3072
    buffer_load_dwordx4 v[132:135], v3, s[36:39], s83 offen offset:3072
    s_setprio 0
    s_mov_b32 s50, 6
    s_add_u32 s80, s80, 4096
    s_add_u32 s81, s81, 4096
    s_add_u32 s82, s82, 4096
    s_add_u32 s83, s83, 4096
    s_waitcnt vmcnt(12)
    v_mfma_f32_32x32x16_bf16 v[56:71], v[80:83], v[84:87], 0
    v_mfma_f32_32x32x16_bf16 v[40:55], v[80:83], v[76:79], 0
    v_mfma_f32_32x32x16_bf16 v[24:39], v[72:75], v[84:87], 0
    v_mfma_f32_32x32x16_bf16 v[8:23], v[72:75], v[76:79], 0
    s_branch P2_GIN
P2_GLOOP:
    s_add_u32 s80, s80, 4096
    s_add_u32 s81, s81, 4096
    s_add_u32 s82, s82, 4096
    s_add_u32 s83, s83, 4096
    s_waitcnt vmcnt(12)
    v_mfma_f32_32x32x16_bf16 v[56:71], v[80:83], v[84:87], v[56:71]
    v_mfma_f32_32x32x16_bf16 v[40:55], v[80:83], v[76:79], v[40:55]
    v_mfma_f32_32x32x16_bf16 v[24:39], v[72:75], v[84:87], v[24:39]
    v_mfma_f32_32x32x16_bf16 v[8:23], v[72:75], v[76:79], v[8:23]
P2_GIN:
    buffer_load_dwordx4 v[72:75], v3, s[36:39], s80 offen offset:0
    buffer_load_dwordx4 v[76:79], v3, s[36:39], s82 offen offset:0
    buffer_load_dwordx4 v[80:83], v3, s[36:39], s81 offen offset:0
    buffer_load_dwordx4 v[84:87], v3, s[36:39], s83 offen offset:0
    s_waitcnt vmcnt(12)
    v_mfma_f32_32x32x16_bf16 v[56:71], v[96:99], v[100:103], v[56:71]
    v_mfma_f32_32x32x16_bf16 v[40:55], v[96:99], v[92:95], v[40:55]
    v_mfma_f32_32x32x16_bf16 v[24:39], v[88:91], v[100:103], v[24:39]
    v_mfma_f32_32x32x16_bf16 v[8:23], v[88:91], v[92:95], v[8:23]
    buffer_load_dwordx4 v[88:91], v3, s[36:39], s80 offen offset:1024
    buffer_load_dwordx4 v[92:95], v3, s[36:39], s82 offen offset:1024
    buffer_load_dwordx4 v[96:99], v3, s[36:39], s81 offen offset:1024
    buffer_load_dwordx4 v[100:103], v3, s[36:39], s83 offen offset:1024
    s_waitcnt vmcnt(12)
    v_mfma_f32_32x32x16_bf16 v[56:71], v[112:115], v[116:119], v[56:71]
    v_mfma_f32_32x32x16_bf16 v[40:55], v[112:115], v[108:111], v[40:55]
    v_mfma_f32_32x32x16_bf16 v[24:39], v[104:107], v[116:119], v[24:39]
    v_mfma_f32_32x32x16_bf16 v[8:23], v[104:107], v[108:111], v[8:23]
    buffer_load_dwordx4 v[104:107], v3, s[36:39], s80 offen offset:2048
    buffer_load_dwordx4 v[108:111], v3, s[36:39], s82 offen offset:2048
    buffer_load_dwordx4 v[112:115], v3, s[36:39], s81 offen offset:2048
    buffer_load_dwordx4 v[116:119], v3, s[36:39], s83 offen offset:2048
    s_waitcnt vmcnt(12)
    v_mfma_f32_32x32x16_bf16 v[56:71], v[128:131], v[132:135], v[56:71]
    v_mfma_f32_32x32x16_bf16 v[40:55], v[128:131], v[124:127], v[40:55]
    v_mfma_f32_32x32x16_bf16 v[24:39], v[120:123], v[132:135], v[24:39]
    v_mfma_f32_32x32x16_bf16 v[8:23], v[120:123], v[124:127], v[8:23]
    buffer_load_dwordx4 v[120:123], v3, s[36:39], s80 offen offset:3072
    buffer_load_dwordx4 v[124:127], v3, s[36:39], s82 offen offset:3072
    buffer_load_dwordx4 v[128:131], v3, s[36:39], s81 offen offset:3072
    buffer_load_dwordx4 v[132:135], v3, s[36:39], s83 offen offset:3072
    s_sub_u32 s50, s50, 1
    s_cmp_lg_u32 s50, 0
    s_cbranch_scc1 P2_GLOOP
    s_waitcnt vmcnt(12)
    v_mfma_f32_32x32x16_bf16 v[56:71], v[80:83], v[84:87], v[56:71]
    v_mfma_f32_32x32x16_bf16 v[40:55], v[80:83], v[76:79], v[40:55]
    v_mfma_f32_32x32x16_bf16 v[24:39], v[72:75], v[84:87], v[24:39]
    v_mfma_f32_32x32x16_bf16 v[8:23], v[72:75], v[76:79], v[8:23]
    s_waitcnt vmcnt(8)
    v_mfma_f32_32x32x16_bf16 v[56:71], v[96:99], v[100:103], v[56:71]
    v_mfma_f32_32x32x16_bf16 v[40:55], v[96:99], v[92:95], v[40:55]
    v_mfma_f32_32x32x16_bf16 v[24:39], v[88:91], v[100:103], v[24:39]
    v_mfma_f32_32x32x16_bf16 v[8:23], v[88:91], v[92:95], v[8:23]
    s_waitcnt vmcnt(4)
    v_mfma_f32_32x32x16_bf16 v[56:71], v[112:115], v[116:119], v[56:71]
    v_mfma_f32_32x32x16_bf16 v[40:55], v[112:115], v[108:111], v[40:55]
    v_mfma_f32_32x32x16_bf16 v[24:39], v[104:107], v[116:119], v[24:39]
    v_mfma_f32_32x32x16_bf16 v[8:23], v[104:107], v[108:111], v[8:23]
    s_waitcnt vmcnt(0)
    v_mfma_f32_32x32x16_bf16 v[56:71], v[128:131], v[132:135], v[56:71]
    v_mfma_f32_32x32x16_bf16 v[40:55], v[128:131], v[124:127], v[40:55]
    v_mfma_f32_32x32x16_bf16 v[24:39], v[120:123], v[132:135], v[24:39]
    v_mfma_f32_32x32x16_bf16 v[8:23], v[120:123], v[124:127], v[8:23]
    buffer_load_dwordx4 v[72:75], v3, s[36:39], s24 offen offset:0
    buffer_load_dwordx4 v[76:79], v3, s[36:39], s25 offen offset:0
    buffer_load_dwordx4 v[80:83], v3, s[36:39], s24 offen offset:1024
    buffer_load_dwordx4 v[84:87], v3, s[36:39], s25 offen offset:1024
    buffer_load_dwordx4 v[88:91], v3, s[36:39], s24 offen offset:2048
    buffer_load_dwordx4 v[92:95], v3, s[36:39], s25 offen offset:2048
    buffer_load_dwordx4 v[96:99], v3, s[36:39], s24 offen offset:3072
    buffer_load_dwordx4 v[100:103], v3, s[36:39], s25 offen offset:3072
    s_lshl_b32 s84, s63, 13
    s_add_u32 s84, s84, 131072
    s_add_u32 m0, s84, 0
    s_add_u32 s44, s24, 4096
    buffer_load_dwordx4 v3, s[36:39], s44 offen offset:0 lds
    buffer_load_dwordx4 v3, s[36:39], s44 offen offset:1024 lds
    buffer_load_dwordx4 v3, s[36:39], s44 offen offset:2048 lds
    buffer_load_dwordx4 v3, s[36:39], s44 offen offset:3072 lds
    s_add_u32 m0, s84, 4096
    s_add_u32 s44, s25, 4096
    buffer_load_dwordx4 v3, s[36:39], s44 offen offset:0 lds
    buffer_load_dwordx4 v3, s[36:39], s44 offen offset:1024 lds
    buffer_load_dwordx4 v3, s[36:39], s44 offen offset:2048 lds
    buffer_load_dwordx4 v3, s[36:39], s44 offen offset:3072 lds
    s_setprio 3
P2_F3P:
    buffer_load_dwordx2 v[160:161], v7, s[36:39], s20 offen sc0 sc1
    s_waitcnt vmcnt(0)
    v_cmp_eq_u64 vcc, s[8:9], v[160:161]
    s_nop 4
    s_cmp_eq_u64 vcc, -1
    s_cbranch_scc1 P2_F3GOT
    s_cmp_eq_u32 s87, 0
    s_cbranch_scc1 P2_F3GOT
    s_sub_u32 s87, s87, 1
    s_sleep 8
    s_branch P2_F3P
P2_F3GOT:
    v_and_b32 v2, 31, v1
    v_lshlrev_b32 v2, 2, v2
    buffer_load_dword v4, v2, s[36:39], s32 offen
    buffer_load_dword v5, v2, s[36:39], s33 offen
    s_waitcnt vmcnt(0)
    v_sub_f32 v4, 1.0, v4
    v_sub_f32 v5, 1.0, v5
    v_mul_f32 v56, v56, v5
    v_mul_f32 v57, v57, v5
    v_mul_f32 v58, v58, v5
    v_mul_f32 v59, v59, v5
    v_mul_f32 v60, v60, v5
    v_mul_f32 v61, v61, v5
    v_mul_f32 v62, v62, v5
    v_mul_f32 v63, v63, v5
    v_mul_f32 v64, v64, v5
    v_mul_f32 v65, v65, v5
    v_mul_f32 v66, v66, v5
    v_mul_f32 v67, v67, v5
    v_mul_f32 v68, v68, v5
    v_mul_f32 v69, v69, v5
    v_mul_f32 v70, v70, v5
    v_mul_f32 v71, v71, v5
    v_mul_f32 v40, v40, v4
    v_mul_f32 v41, v41, v4
    v_mul_f32 v42, v42, v4
    v_mul_f32 v43, v43, v4
    v_mul_f32 v44, v44, v4
    v_mul_f32 v45, v45, v4
    v_mul_f32 v46, v46, v4
    v_mul_f32 v47, v47, v4
    v_mul_f32 v48, v48, v4
    v_mul_f32 v49, v49, v4
    v_mul_f32 v50, v50, v4
    v_mul_f32 v51, v51, v4
    v_mul_f32 v52, v52, v4
    v_mul_f32 v53, v53, v4
    v_mul_f32 v54, v54, v4
    v_mul_f32 v55, v55, v4
    v_mul_f32 v24, v24, v5
    v_mul_f32 v25, v25, v5
    v_mul_f32 v26, v26, v5
    v_mul_f32 v27, v27, v5
    v_mul_f32 v28, v28, v5
    v_mul_f32 v29, v29, v5
    v_mul_f32 v30, v30, v5
    v_mul_f32 v31, v31, v5
    v_mul_f32 v32, v32, v5
    v_mul_f32 v33, v33, v5
    v_mul_f32 v34, v34, v5
    v_mul_f32 v35, v35, v5
    v_mul_f32 v36, v36, v5
    v_mul_f32 v37, v37, v5
    v_mul_f32 v38, v38, v5
    v_mul_f32 v39, v39, v5
    v_mul_f32 v8, v8, v4
    v_mul_f32 v9, v9, v4
    v_mul_f32 v10, v10, v4
    v_mul_f32 v11, v11, v4
    v_mul_f32 v12, v12, v4
    v_mul_f32 v13, v13, v4
    v_mul_f32 v14, v14, v4
    v_mul_f32 v15, v15, v4
    v_mul_f32 v16, v16, v4
    v_mul_f32 v17, v17, v4
    v_mul_f32 v18, v18, v4
    v_mul_f32 v19, v19, v4
    v_mul_f32 v20, v20, v4
    v_mul_f32 v21, v21, v4
    v_mul_f32 v22, v22, v4
    v_mul_f32 v23, v23, v4
    s_add_u32 s85, s26, 4096
    s_add_u32 s86, s27, 4096
    v_add_u32 v2, s84, v3
    s_mul_i32 s44, s63, 12288
    v_add_u32 v4, s44, v3
    s_xor_b32 s44, s63, 1
    s_mul_i32 s44, s44, 12288
    v_add_u32 v5, s44, v3
    s_xor_b32 s44, s63, 2
    s_mul_i32 s44, s44, 12288
    v_add_u32 v6, s44, v3
    s_xor_b32 s44, s63, 3
    s_mul_i32 s44, s44, 12288
    v_add_u32 v7, s44, v3
    s_waitcnt vmcnt(0)
    s_barrier
    buffer_load_dwordx4 v[104:107], v3, s[36:39], s26 offen offset:0 sc0 sc1
    buffer_load_dwordx4 v[108:111], v3, s[36:39], s27 offen offset:0 sc0 sc1
    buffer_load_dwordx4 v[112:115], v3, s[36:39], s26 offen offset:1024 sc0 sc1
    buffer_load_dwordx4 v[116:119], v3, s[36:39], s27 offen offset:1024 sc0 sc1
    buffer_load_dwordx4 v[120:123], v3, s[36:39], s26 offen offset:2048 sc0 sc1
    buffer_load_dwordx4 v[124:127], v3, s[36:39], s27 offen offset:2048 sc0 sc1
    buffer_load_dwordx4 v[128:131], v3, s[36:39], s26 offen offset:3072 sc0 sc1
    buffer_load_dwordx4 v[132:135], v3, s[36:39], s27 offen offset:3072 sc0 sc1
    buffer_load_dwordx4 v[136:139], v3, s[36:39], s85 offen offset:0 sc0 sc1
    buffer_load_dwordx4 v[140:143], v3, s[36:39], s86 offen offset:0 sc0 sc1
    buffer_load_dwordx4 v[144:147], v3, s[36:39], s85 offen offset:1024 sc0 sc1
    buffer_load_dwordx4 v[148:151], v3, s[36:39], s86 offen offset:1024 sc0 sc1
    buffer_load_dwordx4 v[152:155], v3, s[36:39], s85 offen offset:2048 sc0 sc1
    buffer_load_dwordx4 v[156:159], v3, s[36:39], s86 offen offset:2048 sc0 sc1
    buffer_load_dwordx4 v[160:163], v3, s[36:39], s85 offen offset:3072 sc0 sc1
    buffer_load_dwordx4 v[164:167], v3, s[36:39], s86 offen offset:3072 sc0 sc1
P2_CHK0:
    s_waitcnt vmcnt(14)
    v_max3_u32 v0, v104, v105, v106
    v_max3_u32 v0, v107, v108, v0
    v_max3_u32 v0, v109, v110, v0
    v_max_u32 v0, v111, v0
    v_cmp_eq_u32 vcc, -1, v0
    s_nop 0
    s_nop 2
    s_cbranch_vccnz P2_RETRY0
P2_GO0:
    v_mfma_f32_32x32x16_bf16 v[56:71], v[76:79], v[108:111], v[56:71]
    v_mfma_f32_32x32x16_bf16 v[40:55], v[76:79], v[104:107], v[40:55]
    v_mfma_f32_32x32x16_bf16 v[24:39], v[72:75], v[108:111], v[24:39]
    v_mfma_f32_32x32x16_bf16 v[8:23], v[72:75], v[104:107], v[8:23]
    ds_read_b128 v[72:75], v2 offset:0
    ds_read_b128 v[76:79], v2 offset:4096
P2_CHK1:
    s_waitcnt vmcnt(12)
    v_max3_u32 v0, v112, v113, v114
    v_max3_u32 v0, v115, v116, v0
    v_max3_u32 v0, v117, v118, v0
    v_max_u32 v0, v119, v0
    v_cmp_eq_u32 vcc, -1, v0
    s_nop 0
    s_nop 2
    s_cbranch_vccnz P2_RETRY1
P2_GO1:
    v_mfma_f32_32x32x16_bf16 v[56:71], v[84:87], v[116:119], v[56:71]
    v_mfma_f32_32x32x16_bf16 v[40:55], v[84:87], v[112:115], v[40:55]
    v_mfma_f32_32x32x16_bf16 v[24:39], v[80:83], v[116:119], v[24:39]
    v_mfma_f32_32x32x16_bf16 v[8:23], v[80:83], v[112:115], v[8:23]
    ds_read_b128 v[80:83], v2 offset:1024
    ds_read_b128 v[84:87], v2 offset:5120
P2_CHK2:
    s_waitcnt vmcnt(10)
    v_max3_u32 v0, v120, v121, v122
    v_max3_u32 v0, v123, v124, v0
    v_max3_u32 v0, v125, v126, v0
    v_max_u32 v0, v127, v0
    v_cmp_eq_u32 vcc, -1, v0
    s_nop 0
    s_nop 2
    s_cbranch_vccnz P2_RETRY2
P2_GO2:
    v_mfma_f32_32x32x16_bf16 v[56:71], v[92:95], v[124:127], v[56:71]
    v_mfma_f32_32x32x16_bf16 v[40:55], v[92:95], v[120:123], v[40:55]
    v_mfma_f32_32x32x16_bf16 v[24:39], v[88:91], v[124:127], v[24:39]
    v_mfma_f32_32x32x16_bf16 v[8:23], v[88:91], v[120:123], v[8:23]
    ds_read_b128 v[88:91], v2 offset:2048
    ds_read_b128 v[92:95], v2 offset:6144
P2_CHK3:
    s_waitcnt vmcnt(8)
    v_max3_u32 v0, v128, v129, v130
    v_max3_u32 v0, v131, v132, v0
    v_max3_u32 v0, v133, v134, v0
    v_max_u32 v0, v135, v0
    v_cmp_eq_u32 vcc, -1, v0
    s_nop 0
    s_nop 2
    s_cbranch_vccnz P2_RETRY3
P2_GO3:
    v_mfma_f32_32x32x16_bf16 v[56:71], v[100:103], v[132:135], v[56:71]
    v_mfma_f32_32x32x16_bf16 v[40:55], v[100:103], v[128:131], v[40:55]
    v_mfma_f32_32x32x16_bf16 v[24:39], v[96:99], v[132:135], v[24:39]
    v_mfma_f32_32x32x16_bf16 v[8:23], v[96:99], v[128:131], v[8:23]
    ds_read_b128 v[96:99], v2 offset:3072
    ds_read_b128 v[100:103], v2 offset:7168
P2_CHK4:
    s_waitcnt vmcnt(6)
    v_max3_u32 v0, v136, v137, v138
    v_max3_u32 v0, v139, v140, v0
    v_max3_u32 v0, v141, v142, v0
    v_max_u32 v0, v143, v0
    v_cmp_eq_u32 vcc, -1, v0
    s_waitcnt lgkmcnt(6)
    s_nop 2
    s_cbranch_vccnz P2_RETRY4
P2_GO4:
    v_mfma_f32_32x32x16_bf16 v[56:71], v[76:79], v[140:143], v[56:71]
    v_mfma_f32_32x32x16_bf16 v[40:55], v[76:79], v[136:139], v[40:55]
    v_mfma_f32_32x32x16_bf16 v[24:39], v[72:75], v[140:143], v[24:39]
    v_mfma_f32_32x32x16_bf16 v[8:23], v[72:75], v[136:139], v[8:23]
P2_CHK5:
    s_waitcnt vmcnt(4)
    v_max3_u32 v0, v144, v145, v146
    v_max3_u32 v0, v147, v148, v0
    v_max3_u32 v0, v149, v150, v0
    v_max_u32 v0, v151, v0
    v_cmp_eq_u32 vcc, -1, v0
    s_waitcnt lgkmcnt(4)
    s_nop 2
    s_cbranch_vccnz P2_RETRY5
P2_GO5:
    v_mfma_f32_32x32x16_bf16 v[56:71], v[84:87], v[148:151], v[56:71]
    v_mfma_f32_32x32x16_bf16 v[40:55], v[84:87], v[144:147], v[40:55]
    v_mfma_f32_32x32x16_bf16 v[24:39], v[80:83], v[148:151], v[24:39]
    v_mfma_f32_32x32x16_bf16 v[8:23], v[80:83], v[144:147], v[8:23]
P2_CHK6:
    s_waitcnt vmcnt(2)
    v_max3_u32 v0, v152, v153, v154
    v_max3_u32 v0, v155, v156, v0
    v_max3_u32 v0, v157, v158, v0
    v_max_u32 v0, v159, v0
    v_cmp_eq_u32 vcc, -1, v0
    s_waitcnt lgkmcnt(2)
    s_nop 2
    s_cbranch_vccnz P2_RETRY6
P2_GO6:
    v_mfma_f32_32x32x16_bf16 v[56:71], v[92:95], v[156:159], v[56:71]
    v_mfma_f32_32x32x16_bf16 v[40:55], v[92:95], v[152:155], v[40:55]
    v_mfma_f32_32x32x16_bf16 v[24:39], v[88:91], v[156:159], v[24:39]
    v_mfma_f32_32x32x16_bf16 v[8:23], v[88:91], v[152:155], v[8:23]
P2_CHK7:
    s_waitcnt vmcnt(0)
    v_max3_u32 v0, v160, v161, v162
    v_max3_u32 v0, v163, v164, v0
    v_max3_u32 v0, v165, v166, v0
    v_max_u32 v0, v167, v0
    v_cmp_eq_u32 vcc, -1, v0
    s_waitcnt lgkmcnt(0)
    s_nop 2
    s_cbranch_vccnz P2_RETRY7
P2_GO7:
    v_mfma_f32_32x32x16_bf16 v[56:71], v[100:103], v[164:167], v[56:71]
    v_mfma_f32_32x32x16_bf16 v[40:55], v[100:103], v[160:163], v[40:55]
    v_mfma_f32_32x32x16_bf16 v[24:39], v[96:99], v[164:167], v[24:39]
    v_mfma_f32_32x32x16_bf16 v[8:23], v[96:99], v[160:163], v[8:23]
    s_lshl_b32 s44, s23, 15
    s_lshl_b32 s45, s22, 6
    s_add_u32 s44, s44, s45
    v_and_b32 v2, 31, v1
    v_lshlrev_b32 v2, 10, v2
    v_lshrrev_b32 v1, 5, v1
    v_lshl_add_u32 v2, v1, 5, v2
    s_nop 2
    ds_write_b128 v7, v[56:59] offset:8192
    ds_write_b128 v7, v[60:63] offset:9216
    ds_write_b128 v7, v[64:67] offset:10240
    ds_write_b128 v7, v[68:71] offset:11264
    ds_write_b128 v6, v[40:43] offset:4096
    ds_write_b128 v6, v[44:47] offset:5120
    ds_write_b128 v6, v[48:51] offset:6144
    ds_write_b128 v6, v[52:55] offset:7168
    ds_write_b128 v5, v[24:27] offset:0
    ds_write_b128 v5, v[28:31] offset:1024
    ds_write_b128 v5, v[32:35] offset:2048
    ds_write_b128 v5, v[36:39] offset:3072
    s_waitcnt lgkmcnt(0)
    s_barrier
    ds_read_b128 v[72:75], v4 offset:0
    ds_read_b128 v[76:79], v4 offset:1024
    ds_read_b128 v[80:83], v4 offset:2048
    ds_read_b128 v[84:87], v4 offset:3072
    ds_read_b128 v[88:91], v4 offset:4096
    ds_read_b128 v[92:95], v4 offset:5120
    ds_read_b128 v[96:99], v4 offset:6144
    ds_read_b128 v[100:103], v4 offset:7168
    ds_read_b128 v[104:107], v4 offset:8192
    ds_read_b128 v[108:111], v4 offset:9216
    ds_read_b128 v[112:115], v4 offset:10240
    ds_read_b128 v[116:119], v4 offset:11264
    s_waitcnt lgkmcnt(8)
    v_add_f32 v8, v8, v72
    v_add_f32 v9, v9, v73
    v_add_f32 v10, v10, v74
    v_add_f32 v11, v11, v75
    v_add_f32 v12, v12, v76
    v_add_f32 v13, v13, v77
    v_add_f32 v14, v14, v78
    v_add_f32 v15, v15, v79
    v_add_f32 v16, v16, v80
    v_add_f32 v17, v17, v81
    v_add_f32 v18, v18, v82
    v_add_f32 v19, v19, v83
    v_add_f32 v20, v20, v84
    v_add_f32 v21, v21, v85
    v_add_f32 v22, v22, v86
    v_add_f32 v23, v23, v87
    s_waitcnt lgkmcnt(4)
    v_add_f32 v8, v8, v88
    v_add_f32 v9, v9, v89
    v_add_f32 v10, v10, v90
    v_add_f32 v11, v11, v91
    v_add_f32 v12, v12, v92
    v_add_f32 v13, v13, v93
    v_add_f32 v14, v14, v94
    v_add_f32 v15, v15, v95
    v_add_f32 v16, v16, v96
    v_add_f32 v17, v17, v97
    v_add_f32 v18, v18, v98
    v_add_f32 v19, v19, v99
    v_add_f32 v20, v20, v100
    v_add_f32 v21, v21, v101
    v_add_f32 v22, v22, v102
    v_add_f32 v23, v23, v103
    s_waitcnt lgkmcnt(0)
    v_add_f32 v8, v8, v104
    v_add_f32 v9, v9, v105
    v_add_f32 v10, v10, v106
    v_add_f32 v11, v11, v107
    v_add_f32 v12, v12, v108
    v_add_f32 v13, v13, v109
    v_add_f32 v14, v14, v110
    v_add_f32 v15, v15, v111
    v_add_f32 v16, v16, v112
    v_add_f32 v17, v17, v113
    v_add_f32 v18, v18, v114
    v_add_f32 v19, v19, v115
    v_add_f32 v20, v20, v116
    v_add_f32 v21, v21, v117
    v_add_f32 v22, v22, v118
    v_add_f32 v23, v23, v119
    v_cvt_pk_bf16_f32 v72, v8, v9
    v_cvt_pk_bf16_f32 v73, v10, v11
    v_cvt_pk_bf16_f32 v74, v12, v13
    v_cvt_pk_bf16_f32 v75, v14, v15
    v_cvt_pk_bf16_f32 v76, v16, v17
    v_cvt_pk_bf16_f32 v77, v18, v19
    v_cvt_pk_bf16_f32 v78, v20, v21
    v_cvt_pk_bf16_f32 v79, v22, v23
    buffer_store_dwordx4 v[72:75], v2, s[12:15], s44 offen
    buffer_store_dwordx4 v[76:79], v2, s[12:15], s44 offen offset:16
    s_endpgm
P2_RETRY0:
    s_cmp_eq_u32 s87, 0
    s_cbranch_scc1 P2_GO0
    s_sub_u32 s87, s87, 1
    s_sleep 8
    buffer_load_dwordx4 v[104:107], v3, s[36:39], s26 offen offset:0 sc0 sc1
    buffer_load_dwordx4 v[108:111], v3, s[36:39], s27 offen offset:0 sc0 sc1
    buffer_load_dwordx4 v[112:115], v3, s[36:39], s26 offen offset:1024 sc0 sc1
    buffer_load_dwordx4 v[116:119], v3, s[36:39], s27 offen offset:1024 sc0 sc1
    buffer_load_dwordx4 v[120:123], v3, s[36:39], s26 offen offset:2048 sc0 sc1
    buffer_load_dwordx4 v[124:127], v3, s[36:39], s27 offen offset:2048 sc0 sc1
    buffer_load_dwordx4 v[128:131], v3, s[36:39], s26 offen offset:3072 sc0 sc1
    buffer_load_dwordx4 v[132:135], v3, s[36:39], s27 offen offset:3072 sc0 sc1
    buffer_load_dwordx4 v[136:139], v3, s[36:39], s85 offen offset:0 sc0 sc1
    buffer_load_dwordx4 v[140:143], v3, s[36:39], s86 offen offset:0 sc0 sc1
    buffer_load_dwordx4 v[144:147], v3, s[36:39], s85 offen offset:1024 sc0 sc1
    buffer_load_dwordx4 v[148:151], v3, s[36:39], s86 offen offset:1024 sc0 sc1
    buffer_load_dwordx4 v[152:155], v3, s[36:39], s85 offen offset:2048 sc0 sc1
    buffer_load_dwordx4 v[156:159], v3, s[36:39], s86 offen offset:2048 sc0 sc1
    buffer_load_dwordx4 v[160:163], v3, s[36:39], s85 offen offset:3072 sc0 sc1
    buffer_load_dwordx4 v[164:167], v3, s[36:39], s86 offen offset:3072 sc0 sc1
    s_branch P2_CHK0
P2_RETRY1:
    s_cmp_eq_u32 s87, 0
    s_cbranch_scc1 P2_GO1
    s_sub_u32 s87, s87, 1
    s_sleep 8
    buffer_load_dwordx4 v[112:115], v3, s[36:39], s26 offen offset:1024 sc0 sc1
    buffer_load_dwordx4 v[116:119], v3, s[36:39], s27 offen offset:1024 sc0 sc1
    buffer_load_dwordx4 v[120:123], v3, s[36:39], s26 offen offset:2048 sc0 sc1
    buffer_load_dwordx4 v[124:127], v3, s[36:39], s27 offen offset:2048 sc0 sc1
    buffer_load_dwordx4 v[128:131], v3, s[36:39], s26 offen offset:3072 sc0 sc1
    buffer_load_dwordx4 v[132:135], v3, s[36:39], s27 offen offset:3072 sc0 sc1
    buffer_load_dwordx4 v[136:139], v3, s[36:39], s85 offen offset:0 sc0 sc1
    buffer_load_dwordx4 v[140:143], v3, s[36:39], s86 offen offset:0 sc0 sc1
    buffer_load_dwordx4 v[144:147], v3, s[36:39], s85 offen offset:1024 sc0 sc1
    buffer_load_dwordx4 v[148:151], v3, s[36:39], s86 offen offset:1024 sc0 sc1
    buffer_load_dwordx4 v[152:155], v3, s[36:39], s85 offen offset:2048 sc0 sc1
    buffer_load_dwordx4 v[156:159], v3, s[36:39], s86 offen offset:2048 sc0 sc1
    buffer_load_dwordx4 v[160:163], v3, s[36:39], s85 offen offset:3072 sc0 sc1
    buffer_load_dwordx4 v[164:167], v3, s[36:39], s86 offen offset:3072 sc0 sc1
    s_branch P2_CHK1
P2_RETRY2:
    s_cmp_eq_u32 s87, 0
    s_cbranch_scc1 P2_GO2
    s_sub_u32 s87, s87, 1
    s_sleep 8
    buffer_load_dwordx4 v[120:123], v3, s[36:39], s26 offen offset:2048 sc0 sc1
    buffer_load_dwordx4 v[124:127], v3, s[36:39], s27 offen offset:2048 sc0 sc1
    buffer_load_dwordx4 v[128:131], v3, s[36:39], s26 offen offset:3072 sc0 sc1
    buffer_load_dwordx4 v[132:135], v3, s[36:39], s27 offen offset:3072 sc0 sc1
    buffer_load_dwordx4 v[136:139], v3, s[36:39], s85 offen offset:0 sc0 sc1
    buffer_load_dwordx4 v[140:143], v3, s[36:39], s86 offen offset:0 sc0 sc1
    buffer_load_dwordx4 v[144:147], v3, s[36:39], s85 offen offset:1024 sc0 sc1
    buffer_load_dwordx4 v[148:151], v3, s[36:39], s86 offen offset:1024 sc0 sc1
    buffer_load_dwordx4 v[152:155], v3, s[36:39], s85 offen offset:2048 sc0 sc1
    buffer_load_dwordx4 v[156:159], v3, s[36:39], s86 offen offset:2048 sc0 sc1
    buffer_load_dwordx4 v[160:163], v3, s[36:39], s85 offen offset:3072 sc0 sc1
    buffer_load_dwordx4 v[164:167], v3, s[36:39], s86 offen offset:3072 sc0 sc1
    s_branch P2_CHK2
P2_RETRY3:
    s_cmp_eq_u32 s87, 0
    s_cbranch_scc1 P2_GO3
    s_sub_u32 s87, s87, 1
    s_sleep 8
    buffer_load_dwordx4 v[128:131], v3, s[36:39], s26 offen offset:3072 sc0 sc1
    buffer_load_dwordx4 v[132:135], v3, s[36:39], s27 offen offset:3072 sc0 sc1
    buffer_load_dwordx4 v[136:139], v3, s[36:39], s85 offen offset:0 sc0 sc1
    buffer_load_dwordx4 v[140:143], v3, s[36:39], s86 offen offset:0 sc0 sc1
    buffer_load_dwordx4 v[144:147], v3, s[36:39], s85 offen offset:1024 sc0 sc1
    buffer_load_dwordx4 v[148:151], v3, s[36:39], s86 offen offset:1024 sc0 sc1
    buffer_load_dwordx4 v[152:155], v3, s[36:39], s85 offen offset:2048 sc0 sc1
    buffer_load_dwordx4 v[156:159], v3, s[36:39], s86 offen offset:2048 sc0 sc1
    buffer_load_dwordx4 v[160:163], v3, s[36:39], s85 offen offset:3072 sc0 sc1
    buffer_load_dwordx4 v[164:167], v3, s[36:39], s86 offen offset:3072 sc0 sc1
    s_branch P2_CHK3
P2_RETRY4:
    s_cmp_eq_u32 s87, 0
    s_cbranch_scc1 P2_GO4
    s_sub_u32 s87, s87, 1
    s_sleep 8
    buffer_load_dwordx4 v[136:139], v3, s[36:39], s85 offen offset:0 sc0 sc1
    buffer_load_dwordx4 v[140:143], v3, s[36:39], s86 offen offset:0 sc0 sc1
    buffer_load_dwordx4 v[144:147], v3, s[36:39], s85 offen offset:1024 sc0 sc1
    buffer_load_dwordx4 v[148:151], v3, s[36:39], s86 offen offset:1024 sc0 sc1
    buffer_load_dwordx4 v[152:155], v3, s[36:39], s85 offen offset:2048 sc0 sc1
    buffer_load_dwordx4 v[156:159], v3, s[36:39], s86 offen offset:2048 sc0 sc1
    buffer_load_dwordx4 v[160:163], v3, s[36:39], s85 offen offset:3072 sc0 sc1
    buffer_load_dwordx4 v[164:167], v3, s[36:39], s86 offen offset:3072 sc0 sc1
    s_branch P2_CHK4
P2_RETRY5:
    s_cmp_eq_u32 s87, 0
    s_cbranch_scc1 P2_GO5
    s_sub_u32 s87, s87, 1
    s_sleep 8
    buffer_load_dwordx4 v[144:147], v3, s[36:39], s85 offen offset:1024 sc0 sc1
    buffer_load_dwordx4 v[148:151], v3, s[36:39], s86 offen offset:1024 sc0 sc1
    buffer_load_dwordx4 v[152:155], v3, s[36:39], s85 offen offset:2048 sc0 sc1
    buffer_load_dwordx4 v[156:159], v3, s[36:39], s86 offen offset:2048 sc0 sc1
    buffer_load_dwordx4 v[160:163], v3, s[36:39], s85 offen offset:3072 sc0 sc1
    buffer_load_dwordx4 v[164:167], v3, s[36:39], s86 offen offset:3072 sc0 sc1
    s_branch P2_CHK5
P2_RETRY6:
    s_cmp_eq_u32 s87, 0
    s_cbranch_scc1 P2_GO6
    s_sub_u32 s87, s87, 1
    s_sleep 8
    buffer_load_dwordx4 v[152:155], v3, s[36:39], s85 offen offset:2048 sc0 sc1
    buffer_load_dwordx4 v[156:159], v3, s[36:39], s86 offen offset:2048 sc0 sc1
    buffer_load_dwordx4 v[160:163], v3, s[36:39], s85 offen offset:3072 sc0 sc1
    buffer_load_dwordx4 v[164:167], v3, s[36:39], s86 offen offset:3072 sc0 sc1
    s_branch P2_CHK6
P2_RETRY7:
    s_cmp_eq_u32 s87, 0
    s_cbranch_scc1 P2_GO7
    s_sub_u32 s87, s87, 1
    s_sleep 8
    buffer_load_dwordx4 v[160:163], v3, s[36:39], s85 offen offset:3072 sc0 sc1
    buffer_load_dwordx4 v[164:167], v3, s[36:39], s86 offen offset:3072 sc0 sc1
    s_branch P2_CHK7
MK_END:
    s_endpgm
.section .rodata,"a"
.p2align 6
.amdhsa_kernel gated_mix__mha_block__dense_activation_mish__prompt_kernel
  .amdhsa_next_free_vgpr 168
  .amdhsa_next_free_sgpr 102
  .amdhsa_accum_offset 168
  .amdhsa_group_segment_fixed_size 0
  .amdhsa_kernarg_size 88
  .amdhsa_user_sgpr_count 2
  .amdhsa_user_sgpr_kernarg_segment_ptr 1
  .amdhsa_system_sgpr_workgroup_id_x 1
.end_amdhsa_kernel
```
